```python
import torch

def _softmax(x, axis=-1):
    return torch.softmax(x, dim=axis)

def _gelu(x):
    return torch.nn.functional.gelu(x, approximate='tanh')

def _silu(x):
    return torch.nn.functional.silu(x)

def _sigmoid(x):
    return torch.sigmoid(x)

def _layernorm(x, axis=-1, eps=1e-05):
    m = x.mean(dim=axis, keepdim=True)
    v = x.var(dim=axis, keepdim=True, unbiased=False)
    return (x - m) / torch.sqrt(v + eps)

def _scatter_add(tgt, idx, src, axis=0):
    return tgt.clone().index_add_(axis, idx, src)

def _segment_sum(src, seg, n):
    out = torch.zeros((n,) + src.shape[1:], dtype=src.dtype)
    return out.index_add_(0, seg, src)

def _pad(x, pw):
    flat = tuple((v for pair in reversed(pw) for v in pair))
    return torch.nn.functional.pad(x, flat)
kernel_name = 'adaLN_cond__mha_block_cached__swiglu_ffn__decode'

def setup_inputs():

    _w = lambda a: (lambda t: t.to(torch.bfloat16) if t.is_floating_point() else t)(torch.as_tensor(a))

    def _A_setup():
        B, Sq, D = (2, 1, 640)
        H, Sk, Dh = (32, 16384, 128)
        return {'x': _w((lambda *s: torch.randn(*s, dtype=torch.bfloat16) * 0.1)(B, Sq, D)), 'k_cache': _w((lambda *s: torch.randn(*s, dtype=torch.bfloat16) * 0.8)(B, H, Sk, Dh)), 'v_cache': _w((lambda *s: torch.randn(*s, dtype=torch.bfloat16) * 1.6)(B, H, Sk, Dh)), 'wq': _w((lambda *s: torch.randn(*s, dtype=torch.bfloat16) * 0.8)(D, H * Dh) * D ** (-0.5)), 'wo': _w((lambda *s: torch.randn(*s, dtype=torch.bfloat16) * 1.6)(H * Dh, D) * (H * Dh) ** (-0.5))}
    _A_in = _A_setup()

    def _B_setup():
        B, S, D, F = (2, 1, 640, 1728)
        return {'x': _w((lambda *s: torch.randn(*s, dtype=torch.bfloat16) * 0.1)(B, S, D)), 'w_gate': _w((lambda *s: torch.randn(*s, dtype=torch.bfloat16) * 0.1)(D, F)), 'w_up': _w((lambda *s: torch.randn(*s, dtype=torch.bfloat16) * 0.1)(D, F)), 'w_down': _w((lambda *s: torch.randn(*s, dtype=torch.bfloat16) * 0.1)(F, D))}
    _B_in = _B_setup()
    return {'A_x': _A_in['x'], 'A_k_cache': _A_in['k_cache'], 'A_v_cache': _A_in['v_cache'], 'A_wq': _A_in['wq'], 'A_wo': _A_in['wo'], 'B_x': _B_in['x'], 'B_w_gate': _B_in['w_gate'], 'B_w_up': _B_in['w_up'], 'B_w_down': _B_in['w_down'], 'c': _w((lambda *s: torch.randn(*s, dtype=torch.bfloat16) * 0.2)(2, 640) * 8.0), 'w_mod': _w((lambda *s: torch.randn(*s, dtype=torch.bfloat16) * 0.2)(640, 6 * 640) * 640 ** (-0.5) * 8.0)}

def reference(A_x, A_k_cache, A_v_cache, A_wq, A_wo, B_x, B_w_gate, B_w_up, B_w_down, c, w_mod):

    def _A_ref(x, k_cache, v_cache, wq, wo):
        B, Sq, D = x.shape
        H, Dh = (32, 128)
        q = (lambda x, *d: x.permute(*d))((x @ wq).reshape(B, Sq, H, Dh), 0, 2, 1, 3)
        scores = torch.einsum('bhqd,bhkd->bhqk', q, k_cache) * Dh ** (-0.5)
        p = _softmax(scores, axis=-1)
        o = torch.einsum('bhqk,bhkd->bhqd', p, v_cache)
        return (lambda x, *d: x.permute(*d))(o, 0, 2, 1, 3).reshape(B, Sq, H * Dh) @ wo

    def _B_ref(x, w_gate, w_up, w_down):
        g = _silu(x @ w_gate)
        u = x @ w_up
        return g * u @ w_down
    x = A_x
    mod = (_silu(c) @ w_mod).reshape(c.shape[0], 6, 1, -1)
    sa, ca, ga, sb, cb, gb = (mod[:, 0].clone(), mod[:, 1].clone(), mod[:, 2].clone(), mod[:, 3].clone(), mod[:, 4].clone(), mod[:, 5].clone())
    h = _layernorm(x, axis=-1) * (1 + ca) + sa
    x = x + ga * _A_ref(h, A_k_cache, A_v_cache, A_wq, A_wo)
    h = _layernorm(x, axis=-1) * (1 + cb) + sb
    x = x + gb * _B_ref(h, B_w_gate, B_w_up, B_w_down)
    return x
```

```asm
; @launch grid=(256,1,1) block=(512,1,1) lds=159744
.amdgcn_target "amdgcn-amd-amdhsa--gfx950"
.text
.globl adaLN_cond__mha_block_cached__swiglu_ffn__decode_kernel
.p2align 8
.type adaLN_cond__mha_block_cached__swiglu_ffn__decode_kernel,@function
adaLN_cond__mha_block_cached__swiglu_ffn__decode_kernel:
  s_cmp_ge_u32 s2, 256
  s_cbranch_scc1 L_end
  s_load_dwordx16 s[4:19], s[0:1], 0
  s_load_dwordx8 s[20:27], s[0:1], 64
  s_load_dwordx2 s[28:29], s[0:1], 104
  v_lshrrev_b32 v1, 6, v0
  v_and_b32 v0, 63, v0
  v_readfirstlane_b32 s31, v1
  s_lshr_b32 s32, s2, 3
  s_and_b32 s33, s2, 7
  s_mov_b32 s34, 0
  s_mov_b32 s35, 0
  s_cmp_lt_u32 s33, 5
  s_cbranch_scc1 L_roled
  s_mov_b32 s34, 1
  s_mov_b32 s35, s32
  s_cmp_eq_u32 s33, 5
  s_cbranch_scc1 L_roled
  s_mov_b32 s34, 2
  s_cmp_eq_u32 s33, 7
  s_cbranch_scc1 L_roled
  s_mov_b32 s34, 1
  s_add_u32 s35, s32, 32
  s_cmp_lt_u32 s32, 22
  s_cbranch_scc1 L_roled
  s_mov_b32 s34, 2
  s_add_u32 s35, s32, 10
  s_cmp_lt_u32 s32, 30
  s_cbranch_scc1 L_roled
  s_mov_b32 s34, 3
L_roled:
  s_xor_b32 s95, s32, s33
  s_and_b32 s95, s95, 1
  s_xor_b32 s95, s95, 1
  s_lshr_b32 s96, s33, 1
  s_lshl_b32 s57, s32, 2
  s_add_u32 s96, s96, s57
  s_waitcnt lgkmcnt(0)
  s_load_dword s30, s[28:29], 0
  s_mov_b32 s36, s28
  s_and_b32 s37, s29, 0xffff
  s_mov_b32 s38, 0x250000
  s_mov_b32 s39, 0x20000
  s_cmp_ge_u32 s31, 4
  s_cbranch_scc1 L_help
  s_mov_b32 s40, s6
  s_and_b32 s41, s7, 0xffff
  s_mov_b32 s42, 0x10000000
  s_mov_b32 s43, 0x20000
  s_mov_b32 s44, s8
  s_and_b32 s45, s9, 0xffff
  s_mov_b32 s46, 0x10000000
  s_mov_b32 s47, 0x20000
  v_bfe_u32 v1, v0, 2, 2
  v_lshlrev_b32 v2, 8, v1
  v_and_b32 v1, 3, v0
  v_lshl_add_u32 v2, v1, 4, v2
  v_lshrrev_b32 v1, 4, v0
  v_lshl_add_u32 v2, v1, 6, v2
  v_lshlrev_b32 v3, 4, v0
  s_lshl_b32 s57, s33, 2
  s_add_u32 s57, s57, s31
  s_add_u32 s60, s57, 0
  s_add_u32 s61, s57, 32
  s_cmp_eq_u32 s95, 1
  s_cbranch_scc1 L_nopf
  s_lshr_b32 s63, s33, 1
  s_lshl_b32 s63, s63, 2
  s_add_u32 s63, s63, s31
  s_add_u32 s63, s63, 128
  s_lshr_b32 s52, s60, 9
  s_lshl_b32 s52, s52, 5
  s_add_u32 s52, s52, s32
  s_lshl_b32 s52, s52, 22
  s_and_b32 s53, s60, 511
  s_lshl_b32 s53, s53, 13
  s_add_u32 s52, s52, s53
  s_add_u32 s53, s52, 4096
  buffer_load_dwordx4 v[64:67], v2, s[40:43], s52 offen offset:0 nt
  buffer_load_dwordx4 v[68:71], v2, s[40:43], s52 offen offset:1024 nt
  buffer_load_dwordx4 v[72:75], v2, s[40:43], s52 offen offset:2048 nt
  buffer_load_dwordx4 v[76:79], v2, s[40:43], s52 offen offset:3072 nt
  buffer_load_dwordx4 v[80:83], v2, s[40:43], s53 offen offset:0 nt
  buffer_load_dwordx4 v[84:87], v2, s[40:43], s53 offen offset:1024 nt
  buffer_load_dwordx4 v[88:91], v2, s[40:43], s53 offen offset:2048 nt
  buffer_load_dwordx4 v[92:95], v2, s[40:43], s53 offen offset:3072 nt
  buffer_load_dwordx4 v[96:99], v3, s[44:47], s52 offen offset:0 nt
  buffer_load_dwordx4 v[100:103], v3, s[44:47], s52 offen offset:1024 nt
  buffer_load_dwordx4 v[104:107], v3, s[44:47], s52 offen offset:2048 nt
  buffer_load_dwordx4 v[108:111], v3, s[44:47], s52 offen offset:3072 nt
  buffer_load_dwordx4 v[112:115], v3, s[44:47], s53 offen offset:0 nt
  buffer_load_dwordx4 v[116:119], v3, s[44:47], s53 offen offset:1024 nt
  buffer_load_dwordx4 v[120:123], v3, s[44:47], s53 offen offset:2048 nt
  buffer_load_dwordx4 v[124:127], v3, s[44:47], s53 offen offset:3072 nt
  buffer_load_dword v8, v3, s[40:43], s52 offen nt
  s_lshr_b32 s52, s61, 9
  s_lshl_b32 s52, s52, 5
  s_add_u32 s52, s52, s32
  s_lshl_b32 s52, s52, 22
  s_and_b32 s53, s61, 511
  s_lshl_b32 s53, s53, 13
  s_add_u32 s52, s52, s53
  s_add_u32 s53, s52, 4096
  buffer_load_dwordx4 v[128:131], v2, s[40:43], s52 offen offset:0 nt
  buffer_load_dwordx4 v[132:135], v2, s[40:43], s52 offen offset:1024 nt
  buffer_load_dwordx4 v[136:139], v2, s[40:43], s52 offen offset:2048 nt
  buffer_load_dwordx4 v[140:143], v2, s[40:43], s52 offen offset:3072 nt
  buffer_load_dwordx4 v[144:147], v2, s[40:43], s53 offen offset:0 nt
  buffer_load_dwordx4 v[148:151], v2, s[40:43], s53 offen offset:1024 nt
  buffer_load_dwordx4 v[152:155], v2, s[40:43], s53 offen offset:2048 nt
  buffer_load_dwordx4 v[156:159], v2, s[40:43], s53 offen offset:3072 nt
  buffer_load_dwordx4 v[160:163], v3, s[44:47], s52 offen offset:0 nt
  buffer_load_dwordx4 v[164:167], v3, s[44:47], s52 offen offset:1024 nt
  buffer_load_dwordx4 v[168:171], v3, s[44:47], s52 offen offset:2048 nt
  buffer_load_dwordx4 v[172:175], v3, s[44:47], s52 offen offset:3072 nt
  buffer_load_dwordx4 v[176:179], v3, s[44:47], s53 offen offset:0 nt
  buffer_load_dwordx4 v[180:183], v3, s[44:47], s53 offen offset:1024 nt
  buffer_load_dwordx4 v[184:187], v3, s[44:47], s53 offen offset:2048 nt
  buffer_load_dwordx4 v[188:191], v3, s[44:47], s53 offen offset:3072 nt
  buffer_load_dword v8, v3, s[40:43], s52 offen nt
  s_lshr_b32 s52, s63, 9
  s_lshl_b32 s52, s52, 5
  s_add_u32 s52, s52, s32
  s_lshl_b32 s52, s52, 22
  s_and_b32 s53, s63, 511
  s_lshl_b32 s53, s53, 13
  s_add_u32 s52, s52, s53
  s_add_u32 s53, s52, 4096
  buffer_load_dwordx4 v[192:195], v2, s[40:43], s52 offen offset:0 nt
  buffer_load_dwordx4 v[196:199], v2, s[40:43], s52 offen offset:1024 nt
  buffer_load_dwordx4 v[200:203], v2, s[40:43], s52 offen offset:2048 nt
  buffer_load_dwordx4 v[204:207], v2, s[40:43], s52 offen offset:3072 nt
  buffer_load_dwordx4 v[208:211], v2, s[40:43], s53 offen offset:0 nt
  buffer_load_dwordx4 v[212:215], v2, s[40:43], s53 offen offset:1024 nt
  buffer_load_dwordx4 v[216:219], v2, s[40:43], s53 offen offset:2048 nt
  buffer_load_dwordx4 v[220:223], v2, s[40:43], s53 offen offset:3072 nt
  buffer_load_dwordx4 v[224:227], v3, s[44:47], s52 offen offset:0 nt
  buffer_load_dwordx4 v[228:231], v3, s[44:47], s52 offen offset:1024 nt
  buffer_load_dwordx4 v[232:235], v3, s[44:47], s52 offen offset:2048 nt
  buffer_load_dwordx4 v[236:239], v3, s[44:47], s52 offen offset:3072 nt
  buffer_load_dwordx4 v[240:243], v3, s[44:47], s53 offen offset:0 nt
  buffer_load_dwordx4 v[244:247], v3, s[44:47], s53 offen offset:1024 nt
  buffer_load_dwordx4 v[248:251], v3, s[44:47], s53 offen offset:2048 nt
  buffer_load_dwordx4 v[252:255], v3, s[44:47], s53 offen offset:3072 nt
  buffer_load_dword v8, v3, s[40:43], s52 offen nt
  s_waitcnt vmcnt(0)
  s_barrier
L_nopf:
  s_lshl_b32 s58, s32, 13
  s_add_u32 s58, s58, 65536
  v_mov_b32 v4, s58
  s_add_u32 s58, s57, 4294967232
  v_mov_b32 v5, s58
  s_add_u32 s58, s57, 4294967264
  v_mov_b32 v6, s58
  v_and_b32 v1, 15, v0
  v_mov_b32 v36, 0
  v_mov_b32 v37, 0
  v_mov_b32 v38, 0
  v_mov_b32 v39, 0
  v_mov_b32 v14, 0xffff
  v_mov_b32 v15, 0xffff0000
  v_cmp_eq_u32 vcc, 0, v1
  s_nop 1
  v_cndmask_b32 v36, v36, v14, vcc
  v_cmp_eq_u32 vcc, 1, v1
  s_nop 1
  v_cndmask_b32 v36, v36, v15, vcc
  v_cmp_eq_u32 vcc, 2, v1
  s_nop 1
  v_cndmask_b32 v37, v37, v14, vcc
  v_cmp_eq_u32 vcc, 3, v1
  s_nop 1
  v_cndmask_b32 v37, v37, v15, vcc
  v_cmp_eq_u32 vcc, 4, v1
  s_nop 1
  v_cndmask_b32 v38, v38, v14, vcc
  v_cmp_eq_u32 vcc, 5, v1
  s_nop 1
  v_cndmask_b32 v38, v38, v15, vcc
  v_cmp_eq_u32 vcc, 6, v1
  s_nop 1
  v_cndmask_b32 v39, v39, v14, vcc
  v_cmp_eq_u32 vcc, 7, v1
  s_nop 1
  v_cndmask_b32 v39, v39, v15, vcc
  v_mov_b32 v9, 0xf149f2ca
  v_mov_b32 v12, 0xf149f2ca
  v_mov_b32 v13, 0
  v_mov_b32 v16, 0
  v_mov_b32 v17, 0
  v_mov_b32 v18, 0
  v_mov_b32 v19, 0
  s_mov_b32 s55, 0x3e0293ee
  s_mov_b32 s59, 0
  s_mov_b32 s64, 0
  s_waitcnt lgkmcnt(0)
  s_add_u32 s30, s30, 0x9e3779b9
  s_cmp_eq_u32 s95, 1
  s_cbranch_scc0 L_pb1
  s_barrier
  s_barrier
  s_lshr_b32 s52, s60, 9
  s_lshl_b32 s52, s52, 5
  s_add_u32 s52, s52, s32
  s_lshl_b32 s52, s52, 22
  s_and_b32 s53, s60, 511
  s_lshl_b32 s53, s53, 13
  s_add_u32 s52, s52, s53
  s_add_u32 s53, s52, 4096
  buffer_load_dwordx4 v[64:67], v2, s[40:43], s52 offen offset:0 nt
  buffer_load_dwordx4 v[68:71], v2, s[40:43], s52 offen offset:1024 nt
  buffer_load_dwordx4 v[72:75], v2, s[40:43], s52 offen offset:2048 nt
  buffer_load_dwordx4 v[76:79], v2, s[40:43], s52 offen offset:3072 nt
  buffer_load_dwordx4 v[80:83], v2, s[40:43], s53 offen offset:0 nt
  buffer_load_dwordx4 v[84:87], v2, s[40:43], s53 offen offset:1024 nt
  buffer_load_dwordx4 v[88:91], v2, s[40:43], s53 offen offset:2048 nt
  buffer_load_dwordx4 v[92:95], v2, s[40:43], s53 offen offset:3072 nt
  buffer_load_dwordx4 v[96:99], v3, s[44:47], s52 offen offset:0 nt
  buffer_load_dwordx4 v[100:103], v3, s[44:47], s52 offen offset:1024 nt
  buffer_load_dwordx4 v[104:107], v3, s[44:47], s52 offen offset:2048 nt
  buffer_load_dwordx4 v[108:111], v3, s[44:47], s52 offen offset:3072 nt
  buffer_load_dwordx4 v[112:115], v3, s[44:47], s53 offen offset:0 nt
  buffer_load_dwordx4 v[116:119], v3, s[44:47], s53 offen offset:1024 nt
  buffer_load_dwordx4 v[120:123], v3, s[44:47], s53 offen offset:2048 nt
  buffer_load_dwordx4 v[124:127], v3, s[44:47], s53 offen offset:3072 nt
  buffer_load_dword v8, v3, s[40:43], s52 offen nt
  s_lshr_b32 s52, s61, 9
  s_lshl_b32 s52, s52, 5
  s_add_u32 s52, s52, s32
  s_lshl_b32 s52, s52, 22
  s_and_b32 s53, s61, 511
  s_lshl_b32 s53, s53, 13
  s_add_u32 s52, s52, s53
  s_add_u32 s53, s52, 4096
  buffer_load_dwordx4 v[128:131], v2, s[40:43], s52 offen offset:0 nt
  buffer_load_dwordx4 v[132:135], v2, s[40:43], s52 offen offset:1024 nt
  buffer_load_dwordx4 v[136:139], v2, s[40:43], s52 offen offset:2048 nt
  buffer_load_dwordx4 v[140:143], v2, s[40:43], s52 offen offset:3072 nt
  buffer_load_dwordx4 v[144:147], v2, s[40:43], s53 offen offset:0 nt
  buffer_load_dwordx4 v[148:151], v2, s[40:43], s53 offen offset:1024 nt
  buffer_load_dwordx4 v[152:155], v2, s[40:43], s53 offen offset:2048 nt
  buffer_load_dwordx4 v[156:159], v2, s[40:43], s53 offen offset:3072 nt
  buffer_load_dwordx4 v[160:163], v3, s[44:47], s52 offen offset:0 nt
  buffer_load_dwordx4 v[164:167], v3, s[44:47], s52 offen offset:1024 nt
  buffer_load_dwordx4 v[168:171], v3, s[44:47], s52 offen offset:2048 nt
  buffer_load_dwordx4 v[172:175], v3, s[44:47], s52 offen offset:3072 nt
  buffer_load_dwordx4 v[176:179], v3, s[44:47], s53 offen offset:0 nt
  buffer_load_dwordx4 v[180:183], v3, s[44:47], s53 offen offset:1024 nt
  buffer_load_dwordx4 v[184:187], v3, s[44:47], s53 offen offset:2048 nt
  buffer_load_dwordx4 v[188:191], v3, s[44:47], s53 offen offset:3072 nt
  buffer_load_dword v8, v3, s[40:43], s52 offen nt
L_pb1:
  s_barrier
L_pb1x:
  v_bfe_u32 v14, v0, 2, 2
  v_lshrrev_b32 v15, 4, v0
  v_lshl_add_u32 v14, v15, 2, v14
  v_lshlrev_b32 v14, 4, v14
  v_add_u32 v14, 148480, v14
  ds_read_b128 v[28:31], v14
  v_and_b32 v15, 3, v0
  s_waitcnt lgkmcnt(0)
  v_cmp_eq_u32 vcc, 0, v15
  s_nop 1
  v_cndmask_b32 v40, 0, v28, vcc
  v_cndmask_b32 v41, 0, v29, vcc
  v_cndmask_b32 v42, 0, v30, vcc
  v_cndmask_b32 v43, 0, v31, vcc
  v_cmp_eq_u32 vcc, 1, v15
  s_nop 1
  v_cndmask_b32 v44, 0, v28, vcc
  v_cndmask_b32 v45, 0, v29, vcc
  v_cndmask_b32 v46, 0, v30, vcc
  v_cndmask_b32 v47, 0, v31, vcc
  v_cmp_eq_u32 vcc, 2, v15
  s_nop 1
  v_cndmask_b32 v48, 0, v28, vcc
  v_cndmask_b32 v49, 0, v29, vcc
  v_cndmask_b32 v50, 0, v30, vcc
  v_cndmask_b32 v51, 0, v31, vcc
  v_cmp_eq_u32 vcc, 3, v15
  s_nop 1
  v_cndmask_b32 v52, 0, v28, vcc
  v_cndmask_b32 v53, 0, v29, vcc
  v_cndmask_b32 v54, 0, v30, vcc
  v_cndmask_b32 v55, 0, v31, vcc
  s_cmp_eq_u32 s95, 1
  s_cbranch_scc1 L_stream
  s_waitcnt vmcnt(0)
  v_readfirstlane_b32 s58, v5
  v_mfma_f32_16x16x32_bf16 v[20:23], v[64:67], v[40:43], 0
  v_mfma_f32_16x16x32_bf16 v[24:27], v[80:83], v[40:43], 0
  v_mfma_f32_16x16x32_bf16 v[20:23], v[68:71], v[44:47], v[20:23]
  v_mfma_f32_16x16x32_bf16 v[24:27], v[84:87], v[44:47], v[24:27]
  v_mfma_f32_16x16x32_bf16 v[20:23], v[72:75], v[48:51], v[20:23]
  v_mfma_f32_16x16x32_bf16 v[24:27], v[88:91], v[48:51], v[24:27]
  v_mfma_f32_16x16x32_bf16 v[20:23], v[76:79], v[52:55], v[20:23]
  v_mfma_f32_16x16x32_bf16 v[24:27], v[92:95], v[52:55], v[24:27]
  s_nop 7
  v_add_f32_dpp v9, v21, v20 row_ror:12 row_mask:0xf bank_mask:0x1
  v_add_f32_dpp v9, v24, v25 row_ror:4 row_mask:0xf bank_mask:0x2
  v_add_f32_dpp v9, v22, v9 row_ror:8 row_mask:0xf bank_mask:0x1
  v_add_f32_dpp v9, v26, v9 row_ror:12 row_mask:0xf bank_mask:0x2
  v_add_f32_dpp v9, v23, v9 row_ror:4 row_mask:0xf bank_mask:0x1
  v_add_f32_dpp v9, v27, v9 row_ror:8 row_mask:0xf bank_mask:0x2
  s_nop 1
  v_max_f32_dpp v14, v9, v9 row_ror:8 row_mask:0xf bank_mask:0xf
  s_nop 1
  v_max_f32_dpp v14, v14, v14 row_ror:4 row_mask:0xf bank_mask:0xf
  s_nop 1
  v_max_f32_dpp v14, v14, v14 row_ror:2 row_mask:0xf bank_mask:0xf
  s_nop 1
  v_max_f32_dpp v14, v14, v14 row_ror:1 row_mask:0xf bank_mask:0xf
  s_nop 1
  v_max_f32_dpp v14, v14, v14 row_bcast:15 row_mask:0xa bank_mask:0xf
  s_nop 1
  v_max_f32_dpp v14, v14, v14 row_bcast:31 row_mask:0xc bank_mask:0xf
  s_nop 0
  v_readlane_b32 s54, v14, 63
  s_nop 1
  v_max_f32 v14, s54, v12
  v_sub_f32 v15, v12, v14
  v_sub_f32 v10, v9, v14
  v_mul_f32 v15, s55, v15
  v_mul_f32 v10, s55, v10
  v_exp_f32 v15, v15
  v_exp_f32 v10, v10
  v_mov_b32 v12, v14
  v_fma_f32 v13, v13, v15, v10
  v_mul_f32 v16, v16, v15
  v_mul_f32 v17, v17, v15
  v_mul_f32 v18, v18, v15
  v_mul_f32 v19, v19, v15
  v_cvt_pk_bf16_f32 v10, v10, v10
  s_nop 1
  v_and_b32_dpp v28, v10, v36 row_newbcast:0 row_mask:0xf bank_mask:0xf
  v_and_b32_dpp v29, v10, v37 row_newbcast:0 row_mask:0xf bank_mask:0xf
  v_and_b32_dpp v30, v10, v38 row_newbcast:0 row_mask:0xf bank_mask:0xf
  v_and_b32_dpp v31, v10, v39 row_newbcast:0 row_mask:0xf bank_mask:0xf
  v_and_b32_dpp v32, v10, v36 row_newbcast:1 row_mask:0xf bank_mask:0xf
  v_and_b32_dpp v33, v10, v37 row_newbcast:1 row_mask:0xf bank_mask:0xf
  v_and_b32_dpp v34, v10, v38 row_newbcast:1 row_mask:0xf bank_mask:0xf
  v_and_b32_dpp v35, v10, v39 row_newbcast:1 row_mask:0xf bank_mask:0xf
  v_mfma_f32_16x16x32_bf16 v[16:19], v[96:99], v[28:31], v[16:19]
  v_and_b32_dpp v28, v10, v36 row_newbcast:2 row_mask:0xf bank_mask:0xf
  v_and_b32_dpp v29, v10, v37 row_newbcast:2 row_mask:0xf bank_mask:0xf
  v_and_b32_dpp v30, v10, v38 row_newbcast:2 row_mask:0xf bank_mask:0xf
  v_and_b32_dpp v31, v10, v39 row_newbcast:2 row_mask:0xf bank_mask:0xf
  v_mfma_f32_16x16x32_bf16 v[16:19], v[100:103], v[32:35], v[16:19]
  v_and_b32_dpp v32, v10, v36 row_newbcast:3 row_mask:0xf bank_mask:0xf
  v_and_b32_dpp v33, v10, v37 row_newbcast:3 row_mask:0xf bank_mask:0xf
  v_and_b32_dpp v34, v10, v38 row_newbcast:3 row_mask:0xf bank_mask:0xf
  v_and_b32_dpp v35, v10, v39 row_newbcast:3 row_mask:0xf bank_mask:0xf
  v_mfma_f32_16x16x32_bf16 v[16:19], v[104:107], v[28:31], v[16:19]
  v_and_b32_dpp v28, v10, v36 row_newbcast:4 row_mask:0xf bank_mask:0xf
  v_and_b32_dpp v29, v10, v37 row_newbcast:4 row_mask:0xf bank_mask:0xf
  v_and_b32_dpp v30, v10, v38 row_newbcast:4 row_mask:0xf bank_mask:0xf
  v_and_b32_dpp v31, v10, v39 row_newbcast:4 row_mask:0xf bank_mask:0xf
  v_mfma_f32_16x16x32_bf16 v[16:19], v[108:111], v[32:35], v[16:19]
  v_and_b32_dpp v32, v10, v36 row_newbcast:5 row_mask:0xf bank_mask:0xf
  v_and_b32_dpp v33, v10, v37 row_newbcast:5 row_mask:0xf bank_mask:0xf
  v_and_b32_dpp v34, v10, v38 row_newbcast:5 row_mask:0xf bank_mask:0xf
  v_and_b32_dpp v35, v10, v39 row_newbcast:5 row_mask:0xf bank_mask:0xf
  v_mfma_f32_16x16x32_bf16 v[16:19], v[112:115], v[28:31], v[16:19]
  v_and_b32_dpp v28, v10, v36 row_newbcast:6 row_mask:0xf bank_mask:0xf
  v_and_b32_dpp v29, v10, v37 row_newbcast:6 row_mask:0xf bank_mask:0xf
  v_and_b32_dpp v30, v10, v38 row_newbcast:6 row_mask:0xf bank_mask:0xf
  v_and_b32_dpp v31, v10, v39 row_newbcast:6 row_mask:0xf bank_mask:0xf
  v_mfma_f32_16x16x32_bf16 v[16:19], v[116:119], v[32:35], v[16:19]
  v_and_b32_dpp v32, v10, v36 row_newbcast:7 row_mask:0xf bank_mask:0xf
  v_and_b32_dpp v33, v10, v37 row_newbcast:7 row_mask:0xf bank_mask:0xf
  v_and_b32_dpp v34, v10, v38 row_newbcast:7 row_mask:0xf bank_mask:0xf
  v_and_b32_dpp v35, v10, v39 row_newbcast:7 row_mask:0xf bank_mask:0xf
  v_mfma_f32_16x16x32_bf16 v[16:19], v[120:123], v[28:31], v[16:19]
  s_nop 1
  v_mfma_f32_16x16x32_bf16 v[16:19], v[124:127], v[32:35], v[16:19]
  s_add_u32 s60, s58, 128
  s_lshr_b32 s52, s60, 9
  s_lshl_b32 s52, s52, 5
  s_add_u32 s52, s52, s32
  s_lshl_b32 s52, s52, 22
  s_and_b32 s53, s60, 511
  s_lshl_b32 s53, s53, 13
  s_add_u32 s52, s52, s53
  s_add_u32 s53, s52, 4096
  buffer_load_dwordx4 v[64:67], v2, s[40:43], s52 offen offset:0 nt
  buffer_load_dwordx4 v[68:71], v2, s[40:43], s52 offen offset:1024 nt
  buffer_load_dwordx4 v[72:75], v2, s[40:43], s52 offen offset:2048 nt
  buffer_load_dwordx4 v[76:79], v2, s[40:43], s52 offen offset:3072 nt
  buffer_load_dwordx4 v[80:83], v2, s[40:43], s53 offen offset:0 nt
  buffer_load_dwordx4 v[84:87], v2, s[40:43], s53 offen offset:1024 nt
  buffer_load_dwordx4 v[88:91], v2, s[40:43], s53 offen offset:2048 nt
  buffer_load_dwordx4 v[92:95], v2, s[40:43], s53 offen offset:3072 nt
  buffer_load_dwordx4 v[96:99], v3, s[44:47], s52 offen offset:0 nt
  buffer_load_dwordx4 v[100:103], v3, s[44:47], s52 offen offset:1024 nt
  buffer_load_dwordx4 v[104:107], v3, s[44:47], s52 offen offset:2048 nt
  buffer_load_dwordx4 v[108:111], v3, s[44:47], s52 offen offset:3072 nt
  buffer_load_dwordx4 v[112:115], v3, s[44:47], s53 offen offset:0 nt
  buffer_load_dwordx4 v[116:119], v3, s[44:47], s53 offen offset:1024 nt
  buffer_load_dwordx4 v[120:123], v3, s[44:47], s53 offen offset:2048 nt
  buffer_load_dwordx4 v[124:127], v3, s[44:47], s53 offen offset:3072 nt
  v_mov_b32 v5, 1
  s_mov_b64 exec, 1
  buffer_atomic_add v5, v4, s[36:39], 0 offen sc0
  s_mov_b64 exec, -1
  v_readfirstlane_b32 s58, v6
  v_mfma_f32_16x16x32_bf16 v[20:23], v[128:131], v[40:43], 0
  v_mfma_f32_16x16x32_bf16 v[24:27], v[144:147], v[40:43], 0
  v_mfma_f32_16x16x32_bf16 v[20:23], v[132:135], v[44:47], v[20:23]
  v_mfma_f32_16x16x32_bf16 v[24:27], v[148:151], v[44:47], v[24:27]
  v_mfma_f32_16x16x32_bf16 v[20:23], v[136:139], v[48:51], v[20:23]
  v_mfma_f32_16x16x32_bf16 v[24:27], v[152:155], v[48:51], v[24:27]
  v_mfma_f32_16x16x32_bf16 v[20:23], v[140:143], v[52:55], v[20:23]
  v_mfma_f32_16x16x32_bf16 v[24:27], v[156:159], v[52:55], v[24:27]
  s_nop 7
  v_add_f32_dpp v9, v21, v20 row_ror:12 row_mask:0xf bank_mask:0x1
  v_add_f32_dpp v9, v24, v25 row_ror:4 row_mask:0xf bank_mask:0x2
  v_add_f32_dpp v9, v22, v9 row_ror:8 row_mask:0xf bank_mask:0x1
  v_add_f32_dpp v9, v26, v9 row_ror:12 row_mask:0xf bank_mask:0x2
  v_add_f32_dpp v9, v23, v9 row_ror:4 row_mask:0xf bank_mask:0x1
  v_add_f32_dpp v9, v27, v9 row_ror:8 row_mask:0xf bank_mask:0x2
  s_nop 1
  v_max_f32_dpp v14, v9, v9 row_ror:8 row_mask:0xf bank_mask:0xf
  s_nop 1
  v_max_f32_dpp v14, v14, v14 row_ror:4 row_mask:0xf bank_mask:0xf
  s_nop 1
  v_max_f32_dpp v14, v14, v14 row_ror:2 row_mask:0xf bank_mask:0xf
  s_nop 1
  v_max_f32_dpp v14, v14, v14 row_ror:1 row_mask:0xf bank_mask:0xf
  s_nop 1
  v_max_f32_dpp v14, v14, v14 row_bcast:15 row_mask:0xa bank_mask:0xf
  s_nop 1
  v_max_f32_dpp v14, v14, v14 row_bcast:31 row_mask:0xc bank_mask:0xf
  s_nop 0
  v_readlane_b32 s54, v14, 63
  s_nop 1
  v_max_f32 v14, s54, v12
  v_sub_f32 v15, v12, v14
  v_sub_f32 v10, v9, v14
  v_mul_f32 v15, s55, v15
  v_mul_f32 v10, s55, v10
  v_exp_f32 v15, v15
  v_exp_f32 v10, v10
  v_mov_b32 v12, v14
  v_fma_f32 v13, v13, v15, v10
  v_mul_f32 v16, v16, v15
  v_mul_f32 v17, v17, v15
  v_mul_f32 v18, v18, v15
  v_mul_f32 v19, v19, v15
  v_cvt_pk_bf16_f32 v10, v10, v10
  s_nop 1
  v_and_b32_dpp v28, v10, v36 row_newbcast:0 row_mask:0xf bank_mask:0xf
  v_and_b32_dpp v29, v10, v37 row_newbcast:0 row_mask:0xf bank_mask:0xf
  v_and_b32_dpp v30, v10, v38 row_newbcast:0 row_mask:0xf bank_mask:0xf
  v_and_b32_dpp v31, v10, v39 row_newbcast:0 row_mask:0xf bank_mask:0xf
  v_and_b32_dpp v32, v10, v36 row_newbcast:1 row_mask:0xf bank_mask:0xf
  v_and_b32_dpp v33, v10, v37 row_newbcast:1 row_mask:0xf bank_mask:0xf
  v_and_b32_dpp v34, v10, v38 row_newbcast:1 row_mask:0xf bank_mask:0xf
  v_and_b32_dpp v35, v10, v39 row_newbcast:1 row_mask:0xf bank_mask:0xf
  v_mfma_f32_16x16x32_bf16 v[16:19], v[160:163], v[28:31], v[16:19]
  v_and_b32_dpp v28, v10, v36 row_newbcast:2 row_mask:0xf bank_mask:0xf
  v_and_b32_dpp v29, v10, v37 row_newbcast:2 row_mask:0xf bank_mask:0xf
  v_and_b32_dpp v30, v10, v38 row_newbcast:2 row_mask:0xf bank_mask:0xf
  v_and_b32_dpp v31, v10, v39 row_newbcast:2 row_mask:0xf bank_mask:0xf
  v_mfma_f32_16x16x32_bf16 v[16:19], v[164:167], v[32:35], v[16:19]
  v_and_b32_dpp v32, v10, v36 row_newbcast:3 row_mask:0xf bank_mask:0xf
  v_and_b32_dpp v33, v10, v37 row_newbcast:3 row_mask:0xf bank_mask:0xf
  v_and_b32_dpp v34, v10, v38 row_newbcast:3 row_mask:0xf bank_mask:0xf
  v_and_b32_dpp v35, v10, v39 row_newbcast:3 row_mask:0xf bank_mask:0xf
  v_mfma_f32_16x16x32_bf16 v[16:19], v[168:171], v[28:31], v[16:19]
  v_and_b32_dpp v28, v10, v36 row_newbcast:4 row_mask:0xf bank_mask:0xf
  v_and_b32_dpp v29, v10, v37 row_newbcast:4 row_mask:0xf bank_mask:0xf
  v_and_b32_dpp v30, v10, v38 row_newbcast:4 row_mask:0xf bank_mask:0xf
  v_and_b32_dpp v31, v10, v39 row_newbcast:4 row_mask:0xf bank_mask:0xf
  v_mfma_f32_16x16x32_bf16 v[16:19], v[172:175], v[32:35], v[16:19]
  v_and_b32_dpp v32, v10, v36 row_newbcast:5 row_mask:0xf bank_mask:0xf
  v_and_b32_dpp v33, v10, v37 row_newbcast:5 row_mask:0xf bank_mask:0xf
  v_and_b32_dpp v34, v10, v38 row_newbcast:5 row_mask:0xf bank_mask:0xf
  v_and_b32_dpp v35, v10, v39 row_newbcast:5 row_mask:0xf bank_mask:0xf
  v_mfma_f32_16x16x32_bf16 v[16:19], v[176:179], v[28:31], v[16:19]
  v_and_b32_dpp v28, v10, v36 row_newbcast:6 row_mask:0xf bank_mask:0xf
  v_and_b32_dpp v29, v10, v37 row_newbcast:6 row_mask:0xf bank_mask:0xf
  v_and_b32_dpp v30, v10, v38 row_newbcast:6 row_mask:0xf bank_mask:0xf
  v_and_b32_dpp v31, v10, v39 row_newbcast:6 row_mask:0xf bank_mask:0xf
  v_mfma_f32_16x16x32_bf16 v[16:19], v[180:183], v[32:35], v[16:19]
  v_and_b32_dpp v32, v10, v36 row_newbcast:7 row_mask:0xf bank_mask:0xf
  v_and_b32_dpp v33, v10, v37 row_newbcast:7 row_mask:0xf bank_mask:0xf
  v_and_b32_dpp v34, v10, v38 row_newbcast:7 row_mask:0xf bank_mask:0xf
  v_and_b32_dpp v35, v10, v39 row_newbcast:7 row_mask:0xf bank_mask:0xf
  v_mfma_f32_16x16x32_bf16 v[16:19], v[184:187], v[28:31], v[16:19]
  s_nop 1
  v_mfma_f32_16x16x32_bf16 v[16:19], v[188:191], v[32:35], v[16:19]
  s_add_u32 s61, s58, 128
  s_lshr_b32 s52, s61, 9
  s_lshl_b32 s52, s52, 5
  s_add_u32 s52, s52, s32
  s_lshl_b32 s52, s52, 22
  s_and_b32 s53, s61, 511
  s_lshl_b32 s53, s53, 13
  s_add_u32 s52, s52, s53
  s_add_u32 s53, s52, 4096
  buffer_load_dwordx4 v[128:131], v2, s[40:43], s52 offen offset:0 nt
  buffer_load_dwordx4 v[132:135], v2, s[40:43], s52 offen offset:1024 nt
  buffer_load_dwordx4 v[136:139], v2, s[40:43], s52 offen offset:2048 nt
  buffer_load_dwordx4 v[140:143], v2, s[40:43], s52 offen offset:3072 nt
  buffer_load_dwordx4 v[144:147], v2, s[40:43], s53 offen offset:0 nt
  buffer_load_dwordx4 v[148:151], v2, s[40:43], s53 offen offset:1024 nt
  buffer_load_dwordx4 v[152:155], v2, s[40:43], s53 offen offset:2048 nt
  buffer_load_dwordx4 v[156:159], v2, s[40:43], s53 offen offset:3072 nt
  buffer_load_dwordx4 v[160:163], v3, s[44:47], s52 offen offset:0 nt
  buffer_load_dwordx4 v[164:167], v3, s[44:47], s52 offen offset:1024 nt
  buffer_load_dwordx4 v[168:171], v3, s[44:47], s52 offen offset:2048 nt
  buffer_load_dwordx4 v[172:175], v3, s[44:47], s52 offen offset:3072 nt
  buffer_load_dwordx4 v[176:179], v3, s[44:47], s53 offen offset:0 nt
  buffer_load_dwordx4 v[180:183], v3, s[44:47], s53 offen offset:1024 nt
  buffer_load_dwordx4 v[184:187], v3, s[44:47], s53 offen offset:2048 nt
  buffer_load_dwordx4 v[188:191], v3, s[44:47], s53 offen offset:3072 nt
  v_mov_b32 v6, 1
  s_mov_b64 exec, 1
  buffer_atomic_add v6, v4, s[36:39], 0 offen sc0
  s_mov_b64 exec, -1
  v_mfma_f32_16x16x32_bf16 v[20:23], v[192:195], v[40:43], 0
  v_mfma_f32_16x16x32_bf16 v[24:27], v[208:211], v[40:43], 0
  v_mfma_f32_16x16x32_bf16 v[20:23], v[196:199], v[44:47], v[20:23]
  v_mfma_f32_16x16x32_bf16 v[24:27], v[212:215], v[44:47], v[24:27]
  v_mfma_f32_16x16x32_bf16 v[20:23], v[200:203], v[48:51], v[20:23]
  v_mfma_f32_16x16x32_bf16 v[24:27], v[216:219], v[48:51], v[24:27]
  v_mfma_f32_16x16x32_bf16 v[20:23], v[204:207], v[52:55], v[20:23]
  v_mfma_f32_16x16x32_bf16 v[24:27], v[220:223], v[52:55], v[24:27]
  s_nop 7
  v_add_f32_dpp v9, v21, v20 row_ror:12 row_mask:0xf bank_mask:0x1
  v_add_f32_dpp v9, v24, v25 row_ror:4 row_mask:0xf bank_mask:0x2
  v_add_f32_dpp v9, v22, v9 row_ror:8 row_mask:0xf bank_mask:0x1
  v_add_f32_dpp v9, v26, v9 row_ror:12 row_mask:0xf bank_mask:0x2
  v_add_f32_dpp v9, v23, v9 row_ror:4 row_mask:0xf bank_mask:0x1
  v_add_f32_dpp v9, v27, v9 row_ror:8 row_mask:0xf bank_mask:0x2
  s_nop 1
  v_max_f32_dpp v14, v9, v9 row_ror:8 row_mask:0xf bank_mask:0xf
  s_nop 1
  v_max_f32_dpp v14, v14, v14 row_ror:4 row_mask:0xf bank_mask:0xf
  s_nop 1
  v_max_f32_dpp v14, v14, v14 row_ror:2 row_mask:0xf bank_mask:0xf
  s_nop 1
  v_max_f32_dpp v14, v14, v14 row_ror:1 row_mask:0xf bank_mask:0xf
  s_nop 1
  v_max_f32_dpp v14, v14, v14 row_bcast:15 row_mask:0xa bank_mask:0xf
  s_nop 1
  v_max_f32_dpp v14, v14, v14 row_bcast:31 row_mask:0xc bank_mask:0xf
  s_nop 0
  v_readlane_b32 s54, v14, 63
  s_nop 1
  v_max_f32 v14, s54, v12
  v_sub_f32 v15, v12, v14
  v_sub_f32 v10, v9, v14
  v_mul_f32 v15, s55, v15
  v_mul_f32 v10, s55, v10
  v_exp_f32 v15, v15
  v_exp_f32 v10, v10
  v_mov_b32 v12, v14
  v_fma_f32 v13, v13, v15, v10
  v_mul_f32 v16, v16, v15
  v_mul_f32 v17, v17, v15
  v_mul_f32 v18, v18, v15
  v_mul_f32 v19, v19, v15
  v_cvt_pk_bf16_f32 v10, v10, v10
  s_nop 1
  v_and_b32_dpp v28, v10, v36 row_newbcast:0 row_mask:0xf bank_mask:0xf
  v_and_b32_dpp v29, v10, v37 row_newbcast:0 row_mask:0xf bank_mask:0xf
  v_and_b32_dpp v30, v10, v38 row_newbcast:0 row_mask:0xf bank_mask:0xf
  v_and_b32_dpp v31, v10, v39 row_newbcast:0 row_mask:0xf bank_mask:0xf
  v_and_b32_dpp v32, v10, v36 row_newbcast:1 row_mask:0xf bank_mask:0xf
  v_and_b32_dpp v33, v10, v37 row_newbcast:1 row_mask:0xf bank_mask:0xf
  v_and_b32_dpp v34, v10, v38 row_newbcast:1 row_mask:0xf bank_mask:0xf
  v_and_b32_dpp v35, v10, v39 row_newbcast:1 row_mask:0xf bank_mask:0xf
  v_mfma_f32_16x16x32_bf16 v[16:19], v[224:227], v[28:31], v[16:19]
  v_and_b32_dpp v28, v10, v36 row_newbcast:2 row_mask:0xf bank_mask:0xf
  v_and_b32_dpp v29, v10, v37 row_newbcast:2 row_mask:0xf bank_mask:0xf
  v_and_b32_dpp v30, v10, v38 row_newbcast:2 row_mask:0xf bank_mask:0xf
  v_and_b32_dpp v31, v10, v39 row_newbcast:2 row_mask:0xf bank_mask:0xf
  v_mfma_f32_16x16x32_bf16 v[16:19], v[228:231], v[32:35], v[16:19]
  v_and_b32_dpp v32, v10, v36 row_newbcast:3 row_mask:0xf bank_mask:0xf
  v_and_b32_dpp v33, v10, v37 row_newbcast:3 row_mask:0xf bank_mask:0xf
  v_and_b32_dpp v34, v10, v38 row_newbcast:3 row_mask:0xf bank_mask:0xf
  v_and_b32_dpp v35, v10, v39 row_newbcast:3 row_mask:0xf bank_mask:0xf
  v_mfma_f32_16x16x32_bf16 v[16:19], v[232:235], v[28:31], v[16:19]
  v_and_b32_dpp v28, v10, v36 row_newbcast:4 row_mask:0xf bank_mask:0xf
  v_and_b32_dpp v29, v10, v37 row_newbcast:4 row_mask:0xf bank_mask:0xf
  v_and_b32_dpp v30, v10, v38 row_newbcast:4 row_mask:0xf bank_mask:0xf
  v_and_b32_dpp v31, v10, v39 row_newbcast:4 row_mask:0xf bank_mask:0xf
  v_mfma_f32_16x16x32_bf16 v[16:19], v[236:239], v[32:35], v[16:19]
  v_and_b32_dpp v32, v10, v36 row_newbcast:5 row_mask:0xf bank_mask:0xf
  v_and_b32_dpp v33, v10, v37 row_newbcast:5 row_mask:0xf bank_mask:0xf
  v_and_b32_dpp v34, v10, v38 row_newbcast:5 row_mask:0xf bank_mask:0xf
  v_and_b32_dpp v35, v10, v39 row_newbcast:5 row_mask:0xf bank_mask:0xf
  v_mfma_f32_16x16x32_bf16 v[16:19], v[240:243], v[28:31], v[16:19]
  v_and_b32_dpp v28, v10, v36 row_newbcast:6 row_mask:0xf bank_mask:0xf
  v_and_b32_dpp v29, v10, v37 row_newbcast:6 row_mask:0xf bank_mask:0xf
  v_and_b32_dpp v30, v10, v38 row_newbcast:6 row_mask:0xf bank_mask:0xf
  v_and_b32_dpp v31, v10, v39 row_newbcast:6 row_mask:0xf bank_mask:0xf
  v_mfma_f32_16x16x32_bf16 v[16:19], v[244:247], v[32:35], v[16:19]
  v_and_b32_dpp v32, v10, v36 row_newbcast:7 row_mask:0xf bank_mask:0xf
  v_and_b32_dpp v33, v10, v37 row_newbcast:7 row_mask:0xf bank_mask:0xf
  v_and_b32_dpp v34, v10, v38 row_newbcast:7 row_mask:0xf bank_mask:0xf
  v_and_b32_dpp v35, v10, v39 row_newbcast:7 row_mask:0xf bank_mask:0xf
  v_mfma_f32_16x16x32_bf16 v[16:19], v[248:251], v[28:31], v[16:19]
  s_nop 1
  v_mfma_f32_16x16x32_bf16 v[16:19], v[252:255], v[32:35], v[16:19]
  s_barrier
  s_lshl_b32 s57, s31, 14
  s_add_u32 s57, s57, 0
  v_add_u32 v15, s57, v3
  s_nop 7
  ds_read_b128 v[192:195], v15 offset:0
  ds_read_b128 v[196:199], v15 offset:1024
  ds_read_b128 v[200:203], v15 offset:2048
  ds_read_b128 v[204:207], v15 offset:3072
  ds_read_b128 v[208:211], v15 offset:4096
  ds_read_b128 v[212:215], v15 offset:5120
  ds_read_b128 v[216:219], v15 offset:6144
  ds_read_b128 v[220:223], v15 offset:7168
  ds_read_b128 v[224:227], v15 offset:8192
  ds_read_b128 v[228:231], v15 offset:9216
  ds_read_b128 v[232:235], v15 offset:10240
  ds_read_b128 v[236:239], v15 offset:11264
  ds_read_b128 v[240:243], v15 offset:12288
  ds_read_b128 v[244:247], v15 offset:13312
  ds_read_b128 v[248:251], v15 offset:14336
  ds_read_b128 v[252:255], v15 offset:15360
  s_waitcnt lgkmcnt(0)
  v_mfma_f32_16x16x32_bf16 v[20:23], v[192:195], v[40:43], 0
  v_mfma_f32_16x16x32_bf16 v[24:27], v[208:211], v[40:43], 0
  v_mfma_f32_16x16x32_bf16 v[20:23], v[196:199], v[44:47], v[20:23]
  v_mfma_f32_16x16x32_bf16 v[24:27], v[212:215], v[44:47], v[24:27]
  v_mfma_f32_16x16x32_bf16 v[20:23], v[200:203], v[48:51], v[20:23]
  v_mfma_f32_16x16x32_bf16 v[24:27], v[216:219], v[48:51], v[24:27]
  v_mfma_f32_16x16x32_bf16 v[20:23], v[204:207], v[52:55], v[20:23]
  v_mfma_f32_16x16x32_bf16 v[24:27], v[220:223], v[52:55], v[24:27]
  s_nop 7
  v_add_f32_dpp v9, v21, v20 row_ror:12 row_mask:0xf bank_mask:0x1
  v_add_f32_dpp v9, v24, v25 row_ror:4 row_mask:0xf bank_mask:0x2
  v_add_f32_dpp v9, v22, v9 row_ror:8 row_mask:0xf bank_mask:0x1
  v_add_f32_dpp v9, v26, v9 row_ror:12 row_mask:0xf bank_mask:0x2
  v_add_f32_dpp v9, v23, v9 row_ror:4 row_mask:0xf bank_mask:0x1
  v_add_f32_dpp v9, v27, v9 row_ror:8 row_mask:0xf bank_mask:0x2
  s_nop 1
  v_max_f32_dpp v14, v9, v9 row_ror:8 row_mask:0xf bank_mask:0xf
  s_nop 1
  v_max_f32_dpp v14, v14, v14 row_ror:4 row_mask:0xf bank_mask:0xf
  s_nop 1
  v_max_f32_dpp v14, v14, v14 row_ror:2 row_mask:0xf bank_mask:0xf
  s_nop 1
  v_max_f32_dpp v14, v14, v14 row_ror:1 row_mask:0xf bank_mask:0xf
  s_nop 1
  v_max_f32_dpp v14, v14, v14 row_bcast:15 row_mask:0xa bank_mask:0xf
  s_nop 1
  v_max_f32_dpp v14, v14, v14 row_bcast:31 row_mask:0xc bank_mask:0xf
  s_nop 0
  v_readlane_b32 s54, v14, 63
  s_nop 1
  v_max_f32 v14, s54, v12
  v_sub_f32 v15, v12, v14
  v_sub_f32 v10, v9, v14
  v_mul_f32 v15, s55, v15
  v_mul_f32 v10, s55, v10
  v_exp_f32 v15, v15
  v_exp_f32 v10, v10
  v_mov_b32 v12, v14
  v_fma_f32 v13, v13, v15, v10
  v_mul_f32 v16, v16, v15
  v_mul_f32 v17, v17, v15
  v_mul_f32 v18, v18, v15
  v_mul_f32 v19, v19, v15
  v_cvt_pk_bf16_f32 v10, v10, v10
  s_nop 1
  v_and_b32_dpp v28, v10, v36 row_newbcast:0 row_mask:0xf bank_mask:0xf
  v_and_b32_dpp v29, v10, v37 row_newbcast:0 row_mask:0xf bank_mask:0xf
  v_and_b32_dpp v30, v10, v38 row_newbcast:0 row_mask:0xf bank_mask:0xf
  v_and_b32_dpp v31, v10, v39 row_newbcast:0 row_mask:0xf bank_mask:0xf
  v_and_b32_dpp v32, v10, v36 row_newbcast:1 row_mask:0xf bank_mask:0xf
  v_and_b32_dpp v33, v10, v37 row_newbcast:1 row_mask:0xf bank_mask:0xf
  v_and_b32_dpp v34, v10, v38 row_newbcast:1 row_mask:0xf bank_mask:0xf
  v_and_b32_dpp v35, v10, v39 row_newbcast:1 row_mask:0xf bank_mask:0xf
  v_mfma_f32_16x16x32_bf16 v[16:19], v[224:227], v[28:31], v[16:19]
  v_and_b32_dpp v28, v10, v36 row_newbcast:2 row_mask:0xf bank_mask:0xf
  v_and_b32_dpp v29, v10, v37 row_newbcast:2 row_mask:0xf bank_mask:0xf
  v_and_b32_dpp v30, v10, v38 row_newbcast:2 row_mask:0xf bank_mask:0xf
  v_and_b32_dpp v31, v10, v39 row_newbcast:2 row_mask:0xf bank_mask:0xf
  v_mfma_f32_16x16x32_bf16 v[16:19], v[228:231], v[32:35], v[16:19]
  v_and_b32_dpp v32, v10, v36 row_newbcast:3 row_mask:0xf bank_mask:0xf
  v_and_b32_dpp v33, v10, v37 row_newbcast:3 row_mask:0xf bank_mask:0xf
  v_and_b32_dpp v34, v10, v38 row_newbcast:3 row_mask:0xf bank_mask:0xf
  v_and_b32_dpp v35, v10, v39 row_newbcast:3 row_mask:0xf bank_mask:0xf
  v_mfma_f32_16x16x32_bf16 v[16:19], v[232:235], v[28:31], v[16:19]
  v_and_b32_dpp v28, v10, v36 row_newbcast:4 row_mask:0xf bank_mask:0xf
  v_and_b32_dpp v29, v10, v37 row_newbcast:4 row_mask:0xf bank_mask:0xf
  v_and_b32_dpp v30, v10, v38 row_newbcast:4 row_mask:0xf bank_mask:0xf
  v_and_b32_dpp v31, v10, v39 row_newbcast:4 row_mask:0xf bank_mask:0xf
  v_mfma_f32_16x16x32_bf16 v[16:19], v[236:239], v[32:35], v[16:19]
  v_and_b32_dpp v32, v10, v36 row_newbcast:5 row_mask:0xf bank_mask:0xf
  v_and_b32_dpp v33, v10, v37 row_newbcast:5 row_mask:0xf bank_mask:0xf
  v_and_b32_dpp v34, v10, v38 row_newbcast:5 row_mask:0xf bank_mask:0xf
  v_and_b32_dpp v35, v10, v39 row_newbcast:5 row_mask:0xf bank_mask:0xf
  v_mfma_f32_16x16x32_bf16 v[16:19], v[240:243], v[28:31], v[16:19]
  v_and_b32_dpp v28, v10, v36 row_newbcast:6 row_mask:0xf bank_mask:0xf
  v_and_b32_dpp v29, v10, v37 row_newbcast:6 row_mask:0xf bank_mask:0xf
  v_and_b32_dpp v30, v10, v38 row_newbcast:6 row_mask:0xf bank_mask:0xf
  v_and_b32_dpp v31, v10, v39 row_newbcast:6 row_mask:0xf bank_mask:0xf
  v_mfma_f32_16x16x32_bf16 v[16:19], v[244:247], v[32:35], v[16:19]
  v_and_b32_dpp v32, v10, v36 row_newbcast:7 row_mask:0xf bank_mask:0xf
  v_and_b32_dpp v33, v10, v37 row_newbcast:7 row_mask:0xf bank_mask:0xf
  v_and_b32_dpp v34, v10, v38 row_newbcast:7 row_mask:0xf bank_mask:0xf
  v_and_b32_dpp v35, v10, v39 row_newbcast:7 row_mask:0xf bank_mask:0xf
  v_mfma_f32_16x16x32_bf16 v[16:19], v[248:251], v[28:31], v[16:19]
  s_nop 1
  v_mfma_f32_16x16x32_bf16 v[16:19], v[252:255], v[32:35], v[16:19]
  s_lshl_b32 s57, s31, 14
  s_add_u32 s57, s57, 65536
  v_add_u32 v15, s57, v3
  s_nop 7
  ds_read_b128 v[192:195], v15 offset:0
  ds_read_b128 v[196:199], v15 offset:1024
  ds_read_b128 v[200:203], v15 offset:2048
  ds_read_b128 v[204:207], v15 offset:3072
  ds_read_b128 v[208:211], v15 offset:4096
  ds_read_b128 v[212:215], v15 offset:5120
  ds_read_b128 v[216:219], v15 offset:6144
  ds_read_b128 v[220:223], v15 offset:7168
  ds_read_b128 v[224:227], v15 offset:8192
  ds_read_b128 v[228:231], v15 offset:9216
  ds_read_b128 v[232:235], v15 offset:10240
  ds_read_b128 v[236:239], v15 offset:11264
  ds_read_b128 v[240:243], v15 offset:12288
  ds_read_b128 v[244:247], v15 offset:13312
  ds_read_b128 v[248:251], v15 offset:14336
  ds_read_b128 v[252:255], v15 offset:15360
  s_waitcnt lgkmcnt(0)
  s_barrier
  v_mfma_f32_16x16x32_bf16 v[20:23], v[192:195], v[40:43], 0
  v_mfma_f32_16x16x32_bf16 v[24:27], v[208:211], v[40:43], 0
  v_mfma_f32_16x16x32_bf16 v[20:23], v[196:199], v[44:47], v[20:23]
  v_mfma_f32_16x16x32_bf16 v[24:27], v[212:215], v[44:47], v[24:27]
  v_mfma_f32_16x16x32_bf16 v[20:23], v[200:203], v[48:51], v[20:23]
  v_mfma_f32_16x16x32_bf16 v[24:27], v[216:219], v[48:51], v[24:27]
  v_mfma_f32_16x16x32_bf16 v[20:23], v[204:207], v[52:55], v[20:23]
  v_mfma_f32_16x16x32_bf16 v[24:27], v[220:223], v[52:55], v[24:27]
  s_nop 7
  v_add_f32_dpp v9, v21, v20 row_ror:12 row_mask:0xf bank_mask:0x1
  v_add_f32_dpp v9, v24, v25 row_ror:4 row_mask:0xf bank_mask:0x2
  v_add_f32_dpp v9, v22, v9 row_ror:8 row_mask:0xf bank_mask:0x1
  v_add_f32_dpp v9, v26, v9 row_ror:12 row_mask:0xf bank_mask:0x2
  v_add_f32_dpp v9, v23, v9 row_ror:4 row_mask:0xf bank_mask:0x1
  v_add_f32_dpp v9, v27, v9 row_ror:8 row_mask:0xf bank_mask:0x2
  s_nop 1
  v_max_f32_dpp v14, v9, v9 row_ror:8 row_mask:0xf bank_mask:0xf
  s_nop 1
  v_max_f32_dpp v14, v14, v14 row_ror:4 row_mask:0xf bank_mask:0xf
  s_nop 1
  v_max_f32_dpp v14, v14, v14 row_ror:2 row_mask:0xf bank_mask:0xf
  s_nop 1
  v_max_f32_dpp v14, v14, v14 row_ror:1 row_mask:0xf bank_mask:0xf
  s_nop 1
  v_max_f32_dpp v14, v14, v14 row_bcast:15 row_mask:0xa bank_mask:0xf
  s_nop 1
  v_max_f32_dpp v14, v14, v14 row_bcast:31 row_mask:0xc bank_mask:0xf
  s_nop 0
  v_readlane_b32 s54, v14, 63
  s_nop 1
  v_max_f32 v14, s54, v12
  v_sub_f32 v15, v12, v14
  v_sub_f32 v10, v9, v14
  v_mul_f32 v15, s55, v15
  v_mul_f32 v10, s55, v10
  v_exp_f32 v15, v15
  v_exp_f32 v10, v10
  v_mov_b32 v12, v14
  v_fma_f32 v13, v13, v15, v10
  v_mul_f32 v16, v16, v15
  v_mul_f32 v17, v17, v15
  v_mul_f32 v18, v18, v15
  v_mul_f32 v19, v19, v15
  v_cvt_pk_bf16_f32 v10, v10, v10
  s_nop 1
  v_and_b32_dpp v28, v10, v36 row_newbcast:0 row_mask:0xf bank_mask:0xf
  v_and_b32_dpp v29, v10, v37 row_newbcast:0 row_mask:0xf bank_mask:0xf
  v_and_b32_dpp v30, v10, v38 row_newbcast:0 row_mask:0xf bank_mask:0xf
  v_and_b32_dpp v31, v10, v39 row_newbcast:0 row_mask:0xf bank_mask:0xf
  v_and_b32_dpp v32, v10, v36 row_newbcast:1 row_mask:0xf bank_mask:0xf
  v_and_b32_dpp v33, v10, v37 row_newbcast:1 row_mask:0xf bank_mask:0xf
  v_and_b32_dpp v34, v10, v38 row_newbcast:1 row_mask:0xf bank_mask:0xf
  v_and_b32_dpp v35, v10, v39 row_newbcast:1 row_mask:0xf bank_mask:0xf
  v_mfma_f32_16x16x32_bf16 v[16:19], v[224:227], v[28:31], v[16:19]
  v_and_b32_dpp v28, v10, v36 row_newbcast:2 row_mask:0xf bank_mask:0xf
  v_and_b32_dpp v29, v10, v37 row_newbcast:2 row_mask:0xf bank_mask:0xf
  v_and_b32_dpp v30, v10, v38 row_newbcast:2 row_mask:0xf bank_mask:0xf
  v_and_b32_dpp v31, v10, v39 row_newbcast:2 row_mask:0xf bank_mask:0xf
  v_mfma_f32_16x16x32_bf16 v[16:19], v[228:231], v[32:35], v[16:19]
  v_and_b32_dpp v32, v10, v36 row_newbcast:3 row_mask:0xf bank_mask:0xf
  v_and_b32_dpp v33, v10, v37 row_newbcast:3 row_mask:0xf bank_mask:0xf
  v_and_b32_dpp v34, v10, v38 row_newbcast:3 row_mask:0xf bank_mask:0xf
  v_and_b32_dpp v35, v10, v39 row_newbcast:3 row_mask:0xf bank_mask:0xf
  v_mfma_f32_16x16x32_bf16 v[16:19], v[232:235], v[28:31], v[16:19]
  v_and_b32_dpp v28, v10, v36 row_newbcast:4 row_mask:0xf bank_mask:0xf
  v_and_b32_dpp v29, v10, v37 row_newbcast:4 row_mask:0xf bank_mask:0xf
  v_and_b32_dpp v30, v10, v38 row_newbcast:4 row_mask:0xf bank_mask:0xf
  v_and_b32_dpp v31, v10, v39 row_newbcast:4 row_mask:0xf bank_mask:0xf
  v_mfma_f32_16x16x32_bf16 v[16:19], v[236:239], v[32:35], v[16:19]
  v_and_b32_dpp v32, v10, v36 row_newbcast:5 row_mask:0xf bank_mask:0xf
  v_and_b32_dpp v33, v10, v37 row_newbcast:5 row_mask:0xf bank_mask:0xf
  v_and_b32_dpp v34, v10, v38 row_newbcast:5 row_mask:0xf bank_mask:0xf
  v_and_b32_dpp v35, v10, v39 row_newbcast:5 row_mask:0xf bank_mask:0xf
  v_mfma_f32_16x16x32_bf16 v[16:19], v[240:243], v[28:31], v[16:19]
  v_and_b32_dpp v28, v10, v36 row_newbcast:6 row_mask:0xf bank_mask:0xf
  v_and_b32_dpp v29, v10, v37 row_newbcast:6 row_mask:0xf bank_mask:0xf
  v_and_b32_dpp v30, v10, v38 row_newbcast:6 row_mask:0xf bank_mask:0xf
  v_and_b32_dpp v31, v10, v39 row_newbcast:6 row_mask:0xf bank_mask:0xf
  v_mfma_f32_16x16x32_bf16 v[16:19], v[244:247], v[32:35], v[16:19]
  v_and_b32_dpp v32, v10, v36 row_newbcast:7 row_mask:0xf bank_mask:0xf
  v_and_b32_dpp v33, v10, v37 row_newbcast:7 row_mask:0xf bank_mask:0xf
  v_and_b32_dpp v34, v10, v38 row_newbcast:7 row_mask:0xf bank_mask:0xf
  v_and_b32_dpp v35, v10, v39 row_newbcast:7 row_mask:0xf bank_mask:0xf
  v_mfma_f32_16x16x32_bf16 v[16:19], v[248:251], v[28:31], v[16:19]
  s_nop 1
  v_mfma_f32_16x16x32_bf16 v[16:19], v[252:255], v[32:35], v[16:19]
L_stream:
L_pos0:
  s_cmp_ge_u32 s61, 960
  s_cbranch_scc1 L_w90
  s_waitcnt vmcnt(17)
  s_branch L_w170
L_w90:
  s_waitcnt vmcnt(9)
L_w170:
  s_cmp_eq_u32 s64, 0
  s_cbranch_scc1 L_nd0
  s_waitcnt vmcnt(0)
L_nd0:
  s_lshr_b32 s57, s60, 9
  s_min_u32 s57, s57, 1
  s_cmp_lg_u32 s57, s59
  s_cbranch_scc1 L_sw0
L_swr0:
  v_readfirstlane_b32 s58, v5
  s_cmp_ge_u32 s60, 960
  s_cbranch_scc1 L_ch0
  v_mfma_f32_16x16x32_bf16 v[20:23], v[64:67], v[40:43], 0
  v_mfma_f32_16x16x32_bf16 v[24:27], v[80:83], v[40:43], 0
  v_mfma_f32_16x16x32_bf16 v[20:23], v[68:71], v[44:47], v[20:23]
  v_mfma_f32_16x16x32_bf16 v[24:27], v[84:87], v[44:47], v[24:27]
  v_mfma_f32_16x16x32_bf16 v[20:23], v[72:75], v[48:51], v[20:23]
  v_mfma_f32_16x16x32_bf16 v[24:27], v[88:91], v[48:51], v[24:27]
  v_mfma_f32_16x16x32_bf16 v[20:23], v[76:79], v[52:55], v[20:23]
  v_mfma_f32_16x16x32_bf16 v[24:27], v[92:95], v[52:55], v[24:27]
  s_nop 7
  v_add_f32_dpp v9, v21, v20 row_ror:12 row_mask:0xf bank_mask:0x1
  v_add_f32_dpp v9, v24, v25 row_ror:4 row_mask:0xf bank_mask:0x2
  v_add_f32_dpp v9, v22, v9 row_ror:8 row_mask:0xf bank_mask:0x1
  v_add_f32_dpp v9, v26, v9 row_ror:12 row_mask:0xf bank_mask:0x2
  v_add_f32_dpp v9, v23, v9 row_ror:4 row_mask:0xf bank_mask:0x1
  v_add_f32_dpp v9, v27, v9 row_ror:8 row_mask:0xf bank_mask:0x2
  s_nop 1
  v_max_f32_dpp v14, v9, v9 row_ror:8 row_mask:0xf bank_mask:0xf
  s_nop 1
  v_max_f32_dpp v14, v14, v14 row_ror:4 row_mask:0xf bank_mask:0xf
  s_nop 1
  v_max_f32_dpp v14, v14, v14 row_ror:2 row_mask:0xf bank_mask:0xf
  s_nop 1
  v_max_f32_dpp v14, v14, v14 row_ror:1 row_mask:0xf bank_mask:0xf
  s_nop 1
  v_max_f32_dpp v14, v14, v14 row_bcast:15 row_mask:0xa bank_mask:0xf
  s_nop 1
  v_max_f32_dpp v14, v14, v14 row_bcast:31 row_mask:0xc bank_mask:0xf
  s_nop 0
  v_readlane_b32 s54, v14, 63
  s_nop 1
  v_max_f32 v14, s54, v12
  v_sub_f32 v15, v12, v14
  v_sub_f32 v10, v9, v14
  v_mul_f32 v15, s55, v15
  v_mul_f32 v10, s55, v10
  v_exp_f32 v15, v15
  v_exp_f32 v10, v10
  v_mov_b32 v12, v14
  v_fma_f32 v13, v13, v15, v10
  v_mul_f32 v16, v16, v15
  v_mul_f32 v17, v17, v15
  v_mul_f32 v18, v18, v15
  v_mul_f32 v19, v19, v15
  v_cvt_pk_bf16_f32 v10, v10, v10
  s_nop 1
  v_and_b32_dpp v28, v10, v36 row_newbcast:0 row_mask:0xf bank_mask:0xf
  v_and_b32_dpp v29, v10, v37 row_newbcast:0 row_mask:0xf bank_mask:0xf
  v_and_b32_dpp v30, v10, v38 row_newbcast:0 row_mask:0xf bank_mask:0xf
  v_and_b32_dpp v31, v10, v39 row_newbcast:0 row_mask:0xf bank_mask:0xf
  v_and_b32_dpp v32, v10, v36 row_newbcast:1 row_mask:0xf bank_mask:0xf
  v_and_b32_dpp v33, v10, v37 row_newbcast:1 row_mask:0xf bank_mask:0xf
  v_and_b32_dpp v34, v10, v38 row_newbcast:1 row_mask:0xf bank_mask:0xf
  v_and_b32_dpp v35, v10, v39 row_newbcast:1 row_mask:0xf bank_mask:0xf
  v_mfma_f32_16x16x32_bf16 v[16:19], v[96:99], v[28:31], v[16:19]
  v_and_b32_dpp v28, v10, v36 row_newbcast:2 row_mask:0xf bank_mask:0xf
  v_and_b32_dpp v29, v10, v37 row_newbcast:2 row_mask:0xf bank_mask:0xf
  v_and_b32_dpp v30, v10, v38 row_newbcast:2 row_mask:0xf bank_mask:0xf
  v_and_b32_dpp v31, v10, v39 row_newbcast:2 row_mask:0xf bank_mask:0xf
  v_mfma_f32_16x16x32_bf16 v[16:19], v[100:103], v[32:35], v[16:19]
  v_and_b32_dpp v32, v10, v36 row_newbcast:3 row_mask:0xf bank_mask:0xf
  v_and_b32_dpp v33, v10, v37 row_newbcast:3 row_mask:0xf bank_mask:0xf
  v_and_b32_dpp v34, v10, v38 row_newbcast:3 row_mask:0xf bank_mask:0xf
  v_and_b32_dpp v35, v10, v39 row_newbcast:3 row_mask:0xf bank_mask:0xf
  v_mfma_f32_16x16x32_bf16 v[16:19], v[104:107], v[28:31], v[16:19]
  v_and_b32_dpp v28, v10, v36 row_newbcast:4 row_mask:0xf bank_mask:0xf
  v_and_b32_dpp v29, v10, v37 row_newbcast:4 row_mask:0xf bank_mask:0xf
  v_and_b32_dpp v30, v10, v38 row_newbcast:4 row_mask:0xf bank_mask:0xf
  v_and_b32_dpp v31, v10, v39 row_newbcast:4 row_mask:0xf bank_mask:0xf
  v_mfma_f32_16x16x32_bf16 v[16:19], v[108:111], v[32:35], v[16:19]
  v_and_b32_dpp v32, v10, v36 row_newbcast:5 row_mask:0xf bank_mask:0xf
  v_and_b32_dpp v33, v10, v37 row_newbcast:5 row_mask:0xf bank_mask:0xf
  v_and_b32_dpp v34, v10, v38 row_newbcast:5 row_mask:0xf bank_mask:0xf
  v_and_b32_dpp v35, v10, v39 row_newbcast:5 row_mask:0xf bank_mask:0xf
  v_mfma_f32_16x16x32_bf16 v[16:19], v[112:115], v[28:31], v[16:19]
  v_and_b32_dpp v28, v10, v36 row_newbcast:6 row_mask:0xf bank_mask:0xf
  v_and_b32_dpp v29, v10, v37 row_newbcast:6 row_mask:0xf bank_mask:0xf
  v_and_b32_dpp v30, v10, v38 row_newbcast:6 row_mask:0xf bank_mask:0xf
  v_and_b32_dpp v31, v10, v39 row_newbcast:6 row_mask:0xf bank_mask:0xf
  v_mfma_f32_16x16x32_bf16 v[16:19], v[116:119], v[32:35], v[16:19]
  v_and_b32_dpp v32, v10, v36 row_newbcast:7 row_mask:0xf bank_mask:0xf
  v_and_b32_dpp v33, v10, v37 row_newbcast:7 row_mask:0xf bank_mask:0xf
  v_and_b32_dpp v34, v10, v38 row_newbcast:7 row_mask:0xf bank_mask:0xf
  v_and_b32_dpp v35, v10, v39 row_newbcast:7 row_mask:0xf bank_mask:0xf
  v_mfma_f32_16x16x32_bf16 v[16:19], v[120:123], v[28:31], v[16:19]
  s_nop 1
  v_mfma_f32_16x16x32_bf16 v[16:19], v[124:127], v[32:35], v[16:19]
  s_branch L_cd0
L_ch0:
  v_mov_b32 v14, 0xf149f2ca
  v_mfma_f32_16x16x32_bf16 v[20:23], v[64:67], v[40:43], 0
  s_nop 1
  v_mfma_f32_16x16x32_bf16 v[20:23], v[68:71], v[44:47], v[20:23]
  s_nop 1
  v_mfma_f32_16x16x32_bf16 v[20:23], v[72:75], v[48:51], v[20:23]
  s_nop 1
  v_mfma_f32_16x16x32_bf16 v[20:23], v[76:79], v[52:55], v[20:23]
  s_nop 7
  v_mov_b32_dpp v9, v14 quad_perm:[0,1,2,3] row_mask:0xf bank_mask:0x2
  v_add_f32_dpp v9, v21, v20 row_ror:12 row_mask:0xf bank_mask:0x1
  v_add_f32_dpp v9, v22, v9 row_ror:8 row_mask:0xf bank_mask:0x1
  v_add_f32_dpp v9, v23, v9 row_ror:4 row_mask:0xf bank_mask:0x1
  s_nop 1
  v_max_f32_dpp v14, v9, v9 row_ror:8 row_mask:0xf bank_mask:0xf
  s_nop 1
  v_max_f32_dpp v14, v14, v14 row_ror:4 row_mask:0xf bank_mask:0xf
  s_nop 1
  v_max_f32_dpp v14, v14, v14 row_ror:2 row_mask:0xf bank_mask:0xf
  s_nop 1
  v_max_f32_dpp v14, v14, v14 row_ror:1 row_mask:0xf bank_mask:0xf
  s_nop 1
  v_max_f32_dpp v14, v14, v14 row_bcast:15 row_mask:0xa bank_mask:0xf
  s_nop 1
  v_max_f32_dpp v14, v14, v14 row_bcast:31 row_mask:0xc bank_mask:0xf
  s_nop 0
  v_readlane_b32 s54, v14, 63
  s_nop 1
  v_max_f32 v14, s54, v12
  v_sub_f32 v15, v12, v14
  v_sub_f32 v10, v9, v14
  v_mul_f32 v15, s55, v15
  v_mul_f32 v10, s55, v10
  v_exp_f32 v15, v15
  v_exp_f32 v10, v10
  v_mov_b32 v12, v14
  v_fma_f32 v13, v13, v15, v10
  v_mul_f32 v16, v16, v15
  v_mul_f32 v17, v17, v15
  v_mul_f32 v18, v18, v15
  v_mul_f32 v19, v19, v15
  v_cvt_pk_bf16_f32 v10, v10, v10
  s_nop 1
  v_and_b32_dpp v28, v10, v36 row_newbcast:0 row_mask:0xf bank_mask:0xf
  v_and_b32_dpp v29, v10, v37 row_newbcast:0 row_mask:0xf bank_mask:0xf
  v_and_b32_dpp v30, v10, v38 row_newbcast:0 row_mask:0xf bank_mask:0xf
  v_and_b32_dpp v31, v10, v39 row_newbcast:0 row_mask:0xf bank_mask:0xf
  v_and_b32_dpp v32, v10, v36 row_newbcast:1 row_mask:0xf bank_mask:0xf
  v_and_b32_dpp v33, v10, v37 row_newbcast:1 row_mask:0xf bank_mask:0xf
  v_and_b32_dpp v34, v10, v38 row_newbcast:1 row_mask:0xf bank_mask:0xf
  v_and_b32_dpp v35, v10, v39 row_newbcast:1 row_mask:0xf bank_mask:0xf
  v_mfma_f32_16x16x32_bf16 v[16:19], v[96:99], v[28:31], v[16:19]
  v_and_b32_dpp v28, v10, v36 row_newbcast:2 row_mask:0xf bank_mask:0xf
  v_and_b32_dpp v29, v10, v37 row_newbcast:2 row_mask:0xf bank_mask:0xf
  v_and_b32_dpp v30, v10, v38 row_newbcast:2 row_mask:0xf bank_mask:0xf
  v_and_b32_dpp v31, v10, v39 row_newbcast:2 row_mask:0xf bank_mask:0xf
  v_mfma_f32_16x16x32_bf16 v[16:19], v[100:103], v[32:35], v[16:19]
  v_and_b32_dpp v32, v10, v36 row_newbcast:3 row_mask:0xf bank_mask:0xf
  v_and_b32_dpp v33, v10, v37 row_newbcast:3 row_mask:0xf bank_mask:0xf
  v_and_b32_dpp v34, v10, v38 row_newbcast:3 row_mask:0xf bank_mask:0xf
  v_and_b32_dpp v35, v10, v39 row_newbcast:3 row_mask:0xf bank_mask:0xf
  v_mfma_f32_16x16x32_bf16 v[16:19], v[104:107], v[28:31], v[16:19]
  s_nop 1
  v_mfma_f32_16x16x32_bf16 v[16:19], v[108:111], v[32:35], v[16:19]
L_cd0:
  s_cmp_eq_u32 s64, 0
  s_cbranch_scc0 L_dr0
  s_add_u32 s60, s58, 128
  s_cmp_ge_u32 s60, 1088
  s_cbranch_scc1 L_stop0
  s_cmp_ge_u32 s60, 960
  s_cbranch_scc0 L_lf0
  s_sub_u32 s53, s60, 960
  s_lshl_b32 s53, s53, 12
  s_add_u32 s53, s53, 3670016
  s_add_u32 s52, s32, 32
  s_lshl_b32 s52, s52, 22
  s_add_u32 s52, s52, s53
  buffer_load_dwordx4 v[64:67], v2, s[40:43], s52 offen offset:0 nt
  buffer_load_dwordx4 v[68:71], v2, s[40:43], s52 offen offset:1024 nt
  buffer_load_dwordx4 v[72:75], v2, s[40:43], s52 offen offset:2048 nt
  buffer_load_dwordx4 v[76:79], v2, s[40:43], s52 offen offset:3072 nt
  buffer_load_dwordx4 v[96:99], v3, s[44:47], s52 offen offset:0 nt
  buffer_load_dwordx4 v[100:103], v3, s[44:47], s52 offen offset:1024 nt
  buffer_load_dwordx4 v[104:107], v3, s[44:47], s52 offen offset:2048 nt
  buffer_load_dwordx4 v[108:111], v3, s[44:47], s52 offen offset:3072 nt
  v_mov_b32 v5, 1
  s_mov_b64 exec, 1
  buffer_atomic_add v5, v4, s[36:39], 0 offen sc0
  s_mov_b64 exec, -1
  s_branch L_pos1
L_lf0:
  s_lshr_b32 s52, s60, 9
  s_lshl_b32 s52, s52, 5
  s_add_u32 s52, s52, s32
  s_lshl_b32 s52, s52, 22
  s_and_b32 s53, s60, 511
  s_lshl_b32 s53, s53, 13
  s_add_u32 s52, s52, s53
  s_add_u32 s53, s52, 4096
  buffer_load_dwordx4 v[64:67], v2, s[40:43], s52 offen offset:0 nt
  buffer_load_dwordx4 v[68:71], v2, s[40:43], s52 offen offset:1024 nt
  buffer_load_dwordx4 v[72:75], v2, s[40:43], s52 offen offset:2048 nt
  buffer_load_dwordx4 v[76:79], v2, s[40:43], s52 offen offset:3072 nt
  buffer_load_dwordx4 v[80:83], v2, s[40:43], s53 offen offset:0 nt
  buffer_load_dwordx4 v[84:87], v2, s[40:43], s53 offen offset:1024 nt
  buffer_load_dwordx4 v[88:91], v2, s[40:43], s53 offen offset:2048 nt
  buffer_load_dwordx4 v[92:95], v2, s[40:43], s53 offen offset:3072 nt
  buffer_load_dwordx4 v[96:99], v3, s[44:47], s52 offen offset:0 nt
  buffer_load_dwordx4 v[100:103], v3, s[44:47], s52 offen offset:1024 nt
  buffer_load_dwordx4 v[104:107], v3, s[44:47], s52 offen offset:2048 nt
  buffer_load_dwordx4 v[108:111], v3, s[44:47], s52 offen offset:3072 nt
  buffer_load_dwordx4 v[112:115], v3, s[44:47], s53 offen offset:0 nt
  buffer_load_dwordx4 v[116:119], v3, s[44:47], s53 offen offset:1024 nt
  buffer_load_dwordx4 v[120:123], v3, s[44:47], s53 offen offset:2048 nt
  buffer_load_dwordx4 v[124:127], v3, s[44:47], s53 offen offset:3072 nt
  v_mov_b32 v5, 1
  s_mov_b64 exec, 1
  buffer_atomic_add v5, v4, s[36:39], 0 offen sc0
  s_mov_b64 exec, -1
L_pos1:
  s_cmp_ge_u32 s60, 960
  s_cbranch_scc1 L_w91
  s_waitcnt vmcnt(17)
  s_branch L_w171
L_w91:
  s_waitcnt vmcnt(9)
L_w171:
  s_cmp_eq_u32 s64, 0
  s_cbranch_scc1 L_nd1
  s_waitcnt vmcnt(0)
L_nd1:
  s_lshr_b32 s57, s61, 9
  s_min_u32 s57, s57, 1
  s_cmp_lg_u32 s57, s59
  s_cbranch_scc1 L_sw1
L_swr1:
  v_readfirstlane_b32 s58, v6
  s_cmp_ge_u32 s61, 960
  s_cbranch_scc1 L_ch1
  v_mfma_f32_16x16x32_bf16 v[20:23], v[128:131], v[40:43], 0
  v_mfma_f32_16x16x32_bf16 v[24:27], v[144:147], v[40:43], 0
  v_mfma_f32_16x16x32_bf16 v[20:23], v[132:135], v[44:47], v[20:23]
  v_mfma_f32_16x16x32_bf16 v[24:27], v[148:151], v[44:47], v[24:27]
  v_mfma_f32_16x16x32_bf16 v[20:23], v[136:139], v[48:51], v[20:23]
  v_mfma_f32_16x16x32_bf16 v[24:27], v[152:155], v[48:51], v[24:27]
  v_mfma_f32_16x16x32_bf16 v[20:23], v[140:143], v[52:55], v[20:23]
  v_mfma_f32_16x16x32_bf16 v[24:27], v[156:159], v[52:55], v[24:27]
  s_nop 7
  v_add_f32_dpp v9, v21, v20 row_ror:12 row_mask:0xf bank_mask:0x1
  v_add_f32_dpp v9, v24, v25 row_ror:4 row_mask:0xf bank_mask:0x2
  v_add_f32_dpp v9, v22, v9 row_ror:8 row_mask:0xf bank_mask:0x1
  v_add_f32_dpp v9, v26, v9 row_ror:12 row_mask:0xf bank_mask:0x2
  v_add_f32_dpp v9, v23, v9 row_ror:4 row_mask:0xf bank_mask:0x1
  v_add_f32_dpp v9, v27, v9 row_ror:8 row_mask:0xf bank_mask:0x2
  s_nop 1
  v_max_f32_dpp v14, v9, v9 row_ror:8 row_mask:0xf bank_mask:0xf
  s_nop 1
  v_max_f32_dpp v14, v14, v14 row_ror:4 row_mask:0xf bank_mask:0xf
  s_nop 1
  v_max_f32_dpp v14, v14, v14 row_ror:2 row_mask:0xf bank_mask:0xf
  s_nop 1
  v_max_f32_dpp v14, v14, v14 row_ror:1 row_mask:0xf bank_mask:0xf
  s_nop 1
  v_max_f32_dpp v14, v14, v14 row_bcast:15 row_mask:0xa bank_mask:0xf
  s_nop 1
  v_max_f32_dpp v14, v14, v14 row_bcast:31 row_mask:0xc bank_mask:0xf
  s_nop 0
  v_readlane_b32 s54, v14, 63
  s_nop 1
  v_max_f32 v14, s54, v12
  v_sub_f32 v15, v12, v14
  v_sub_f32 v10, v9, v14
  v_mul_f32 v15, s55, v15
  v_mul_f32 v10, s55, v10
  v_exp_f32 v15, v15
  v_exp_f32 v10, v10
  v_mov_b32 v12, v14
  v_fma_f32 v13, v13, v15, v10
  v_mul_f32 v16, v16, v15
  v_mul_f32 v17, v17, v15
  v_mul_f32 v18, v18, v15
  v_mul_f32 v19, v19, v15
  v_cvt_pk_bf16_f32 v10, v10, v10
  s_nop 1
  v_and_b32_dpp v28, v10, v36 row_newbcast:0 row_mask:0xf bank_mask:0xf
  v_and_b32_dpp v29, v10, v37 row_newbcast:0 row_mask:0xf bank_mask:0xf
  v_and_b32_dpp v30, v10, v38 row_newbcast:0 row_mask:0xf bank_mask:0xf
  v_and_b32_dpp v31, v10, v39 row_newbcast:0 row_mask:0xf bank_mask:0xf
  v_and_b32_dpp v32, v10, v36 row_newbcast:1 row_mask:0xf bank_mask:0xf
  v_and_b32_dpp v33, v10, v37 row_newbcast:1 row_mask:0xf bank_mask:0xf
  v_and_b32_dpp v34, v10, v38 row_newbcast:1 row_mask:0xf bank_mask:0xf
  v_and_b32_dpp v35, v10, v39 row_newbcast:1 row_mask:0xf bank_mask:0xf
  v_mfma_f32_16x16x32_bf16 v[16:19], v[160:163], v[28:31], v[16:19]
  v_and_b32_dpp v28, v10, v36 row_newbcast:2 row_mask:0xf bank_mask:0xf
  v_and_b32_dpp v29, v10, v37 row_newbcast:2 row_mask:0xf bank_mask:0xf
  v_and_b32_dpp v30, v10, v38 row_newbcast:2 row_mask:0xf bank_mask:0xf
  v_and_b32_dpp v31, v10, v39 row_newbcast:2 row_mask:0xf bank_mask:0xf
  v_mfma_f32_16x16x32_bf16 v[16:19], v[164:167], v[32:35], v[16:19]
  v_and_b32_dpp v32, v10, v36 row_newbcast:3 row_mask:0xf bank_mask:0xf
  v_and_b32_dpp v33, v10, v37 row_newbcast:3 row_mask:0xf bank_mask:0xf
  v_and_b32_dpp v34, v10, v38 row_newbcast:3 row_mask:0xf bank_mask:0xf
  v_and_b32_dpp v35, v10, v39 row_newbcast:3 row_mask:0xf bank_mask:0xf
  v_mfma_f32_16x16x32_bf16 v[16:19], v[168:171], v[28:31], v[16:19]
  v_and_b32_dpp v28, v10, v36 row_newbcast:4 row_mask:0xf bank_mask:0xf
  v_and_b32_dpp v29, v10, v37 row_newbcast:4 row_mask:0xf bank_mask:0xf
  v_and_b32_dpp v30, v10, v38 row_newbcast:4 row_mask:0xf bank_mask:0xf
  v_and_b32_dpp v31, v10, v39 row_newbcast:4 row_mask:0xf bank_mask:0xf
  v_mfma_f32_16x16x32_bf16 v[16:19], v[172:175], v[32:35], v[16:19]
  v_and_b32_dpp v32, v10, v36 row_newbcast:5 row_mask:0xf bank_mask:0xf
  v_and_b32_dpp v33, v10, v37 row_newbcast:5 row_mask:0xf bank_mask:0xf
  v_and_b32_dpp v34, v10, v38 row_newbcast:5 row_mask:0xf bank_mask:0xf
  v_and_b32_dpp v35, v10, v39 row_newbcast:5 row_mask:0xf bank_mask:0xf
  v_mfma_f32_16x16x32_bf16 v[16:19], v[176:179], v[28:31], v[16:19]
  v_and_b32_dpp v28, v10, v36 row_newbcast:6 row_mask:0xf bank_mask:0xf
  v_and_b32_dpp v29, v10, v37 row_newbcast:6 row_mask:0xf bank_mask:0xf
  v_and_b32_dpp v30, v10, v38 row_newbcast:6 row_mask:0xf bank_mask:0xf
  v_and_b32_dpp v31, v10, v39 row_newbcast:6 row_mask:0xf bank_mask:0xf
  v_mfma_f32_16x16x32_bf16 v[16:19], v[180:183], v[32:35], v[16:19]
  v_and_b32_dpp v32, v10, v36 row_newbcast:7 row_mask:0xf bank_mask:0xf
  v_and_b32_dpp v33, v10, v37 row_newbcast:7 row_mask:0xf bank_mask:0xf
  v_and_b32_dpp v34, v10, v38 row_newbcast:7 row_mask:0xf bank_mask:0xf
  v_and_b32_dpp v35, v10, v39 row_newbcast:7 row_mask:0xf bank_mask:0xf
  v_mfma_f32_16x16x32_bf16 v[16:19], v[184:187], v[28:31], v[16:19]
  s_nop 1
  v_mfma_f32_16x16x32_bf16 v[16:19], v[188:191], v[32:35], v[16:19]
  s_branch L_cd1
L_ch1:
  v_mov_b32 v14, 0xf149f2ca
  v_mfma_f32_16x16x32_bf16 v[20:23], v[128:131], v[40:43], 0
  s_nop 1
  v_mfma_f32_16x16x32_bf16 v[20:23], v[132:135], v[44:47], v[20:23]
  s_nop 1
  v_mfma_f32_16x16x32_bf16 v[20:23], v[136:139], v[48:51], v[20:23]
  s_nop 1
  v_mfma_f32_16x16x32_bf16 v[20:23], v[140:143], v[52:55], v[20:23]
  s_nop 7
  v_mov_b32_dpp v9, v14 quad_perm:[0,1,2,3] row_mask:0xf bank_mask:0x2
  v_add_f32_dpp v9, v21, v20 row_ror:12 row_mask:0xf bank_mask:0x1
  v_add_f32_dpp v9, v22, v9 row_ror:8 row_mask:0xf bank_mask:0x1
  v_add_f32_dpp v9, v23, v9 row_ror:4 row_mask:0xf bank_mask:0x1
  s_nop 1
  v_max_f32_dpp v14, v9, v9 row_ror:8 row_mask:0xf bank_mask:0xf
  s_nop 1
  v_max_f32_dpp v14, v14, v14 row_ror:4 row_mask:0xf bank_mask:0xf
  s_nop 1
  v_max_f32_dpp v14, v14, v14 row_ror:2 row_mask:0xf bank_mask:0xf
  s_nop 1
  v_max_f32_dpp v14, v14, v14 row_ror:1 row_mask:0xf bank_mask:0xf
  s_nop 1
  v_max_f32_dpp v14, v14, v14 row_bcast:15 row_mask:0xa bank_mask:0xf
  s_nop 1
  v_max_f32_dpp v14, v14, v14 row_bcast:31 row_mask:0xc bank_mask:0xf
  s_nop 0
  v_readlane_b32 s54, v14, 63
  s_nop 1
  v_max_f32 v14, s54, v12
  v_sub_f32 v15, v12, v14
  v_sub_f32 v10, v9, v14
  v_mul_f32 v15, s55, v15
  v_mul_f32 v10, s55, v10
  v_exp_f32 v15, v15
  v_exp_f32 v10, v10
  v_mov_b32 v12, v14
  v_fma_f32 v13, v13, v15, v10
  v_mul_f32 v16, v16, v15
  v_mul_f32 v17, v17, v15
  v_mul_f32 v18, v18, v15
  v_mul_f32 v19, v19, v15
  v_cvt_pk_bf16_f32 v10, v10, v10
  s_nop 1
  v_and_b32_dpp v28, v10, v36 row_newbcast:0 row_mask:0xf bank_mask:0xf
  v_and_b32_dpp v29, v10, v37 row_newbcast:0 row_mask:0xf bank_mask:0xf
  v_and_b32_dpp v30, v10, v38 row_newbcast:0 row_mask:0xf bank_mask:0xf
  v_and_b32_dpp v31, v10, v39 row_newbcast:0 row_mask:0xf bank_mask:0xf
  v_and_b32_dpp v32, v10, v36 row_newbcast:1 row_mask:0xf bank_mask:0xf
  v_and_b32_dpp v33, v10, v37 row_newbcast:1 row_mask:0xf bank_mask:0xf
  v_and_b32_dpp v34, v10, v38 row_newbcast:1 row_mask:0xf bank_mask:0xf
  v_and_b32_dpp v35, v10, v39 row_newbcast:1 row_mask:0xf bank_mask:0xf
  v_mfma_f32_16x16x32_bf16 v[16:19], v[160:163], v[28:31], v[16:19]
  v_and_b32_dpp v28, v10, v36 row_newbcast:2 row_mask:0xf bank_mask:0xf
  v_and_b32_dpp v29, v10, v37 row_newbcast:2 row_mask:0xf bank_mask:0xf
  v_and_b32_dpp v30, v10, v38 row_newbcast:2 row_mask:0xf bank_mask:0xf
  v_and_b32_dpp v31, v10, v39 row_newbcast:2 row_mask:0xf bank_mask:0xf
  v_mfma_f32_16x16x32_bf16 v[16:19], v[164:167], v[32:35], v[16:19]
  v_and_b32_dpp v32, v10, v36 row_newbcast:3 row_mask:0xf bank_mask:0xf
  v_and_b32_dpp v33, v10, v37 row_newbcast:3 row_mask:0xf bank_mask:0xf
  v_and_b32_dpp v34, v10, v38 row_newbcast:3 row_mask:0xf bank_mask:0xf
  v_and_b32_dpp v35, v10, v39 row_newbcast:3 row_mask:0xf bank_mask:0xf
  v_mfma_f32_16x16x32_bf16 v[16:19], v[168:171], v[28:31], v[16:19]
  s_nop 1
  v_mfma_f32_16x16x32_bf16 v[16:19], v[172:175], v[32:35], v[16:19]
L_cd1:
  s_cmp_eq_u32 s64, 0
  s_cbranch_scc0 L_dr1
  s_add_u32 s61, s58, 128
  s_cmp_ge_u32 s61, 1088
  s_cbranch_scc1 L_stop1
  s_cmp_ge_u32 s61, 960
  s_cbranch_scc0 L_lf1
  s_sub_u32 s53, s61, 960
  s_lshl_b32 s53, s53, 12
  s_add_u32 s53, s53, 3670016
  s_add_u32 s52, s32, 32
  s_lshl_b32 s52, s52, 22
  s_add_u32 s52, s52, s53
  buffer_load_dwordx4 v[128:131], v2, s[40:43], s52 offen offset:0 nt
  buffer_load_dwordx4 v[132:135], v2, s[40:43], s52 offen offset:1024 nt
  buffer_load_dwordx4 v[136:139], v2, s[40:43], s52 offen offset:2048 nt
  buffer_load_dwordx4 v[140:143], v2, s[40:43], s52 offen offset:3072 nt
  buffer_load_dwordx4 v[160:163], v3, s[44:47], s52 offen offset:0 nt
  buffer_load_dwordx4 v[164:167], v3, s[44:47], s52 offen offset:1024 nt
  buffer_load_dwordx4 v[168:171], v3, s[44:47], s52 offen offset:2048 nt
  buffer_load_dwordx4 v[172:175], v3, s[44:47], s52 offen offset:3072 nt
  v_mov_b32 v6, 1
  s_mov_b64 exec, 1
  buffer_atomic_add v6, v4, s[36:39], 0 offen sc0
  s_mov_b64 exec, -1
  s_branch L_pos0
L_lf1:
  s_lshr_b32 s52, s61, 9
  s_lshl_b32 s52, s52, 5
  s_add_u32 s52, s52, s32
  s_lshl_b32 s52, s52, 22
  s_and_b32 s53, s61, 511
  s_lshl_b32 s53, s53, 13
  s_add_u32 s52, s52, s53
  s_add_u32 s53, s52, 4096
  buffer_load_dwordx4 v[128:131], v2, s[40:43], s52 offen offset:0 nt
  buffer_load_dwordx4 v[132:135], v2, s[40:43], s52 offen offset:1024 nt
  buffer_load_dwordx4 v[136:139], v2, s[40:43], s52 offen offset:2048 nt
  buffer_load_dwordx4 v[140:143], v2, s[40:43], s52 offen offset:3072 nt
  buffer_load_dwordx4 v[144:147], v2, s[40:43], s53 offen offset:0 nt
  buffer_load_dwordx4 v[148:151], v2, s[40:43], s53 offen offset:1024 nt
  buffer_load_dwordx4 v[152:155], v2, s[40:43], s53 offen offset:2048 nt
  buffer_load_dwordx4 v[156:159], v2, s[40:43], s53 offen offset:3072 nt
  buffer_load_dwordx4 v[160:163], v3, s[44:47], s52 offen offset:0 nt
  buffer_load_dwordx4 v[164:167], v3, s[44:47], s52 offen offset:1024 nt
  buffer_load_dwordx4 v[168:171], v3, s[44:47], s52 offen offset:2048 nt
  buffer_load_dwordx4 v[172:175], v3, s[44:47], s52 offen offset:3072 nt
  buffer_load_dwordx4 v[176:179], v3, s[44:47], s53 offen offset:0 nt
  buffer_load_dwordx4 v[180:183], v3, s[44:47], s53 offen offset:1024 nt
  buffer_load_dwordx4 v[184:187], v3, s[44:47], s53 offen offset:2048 nt
  buffer_load_dwordx4 v[188:191], v3, s[44:47], s53 offen offset:3072 nt
  v_mov_b32 v6, 1
  s_mov_b64 exec, 1
  buffer_atomic_add v6, v4, s[36:39], 0 offen sc0
  s_mov_b64 exec, -1
  s_branch L_pos0
L_stop0:
  s_mov_b32 s64, 1
  s_branch L_pos1
L_dr0:
  s_sub_u32 s64, s64, 1
  s_cmp_eq_u32 s64, 0
  s_cbranch_scc1 L_sdone
  s_branch L_pos1
L_sw0:
  s_lshl_b32 s57, s31, 1
  s_add_u32 s57, s57, 0
  s_mul_i32 s57, s57, 544
  s_add_u32 s57, s57, 148992
  s_nop 1
  v_add_f32_dpp v14, v13, v13 row_ror:8 row_mask:0xf bank_mask:0xf
  s_nop 1
  v_add_f32_dpp v14, v14, v14 row_ror:4 row_mask:0xf bank_mask:0xf
  s_nop 1
  v_add_f32_dpp v14, v14, v14 row_ror:2 row_mask:0xf bank_mask:0xf
  s_nop 1
  v_add_f32_dpp v14, v14, v14 row_ror:1 row_mask:0xf bank_mask:0xf
  s_nop 1
  v_add_f32_dpp v14, v14, v14 row_bcast:15 row_mask:0xa bank_mask:0xf
  s_nop 1
  v_add_f32_dpp v14, v14, v14 row_bcast:31 row_mask:0xc bank_mask:0xf
  v_lshrrev_b32 v15, 4, v0
  v_lshlrev_b32 v15, 7, v15
  v_and_b32 v1, 15, v0
  v_lshl_add_u32 v15, v1, 2, v15
  v_add_u32 v15, s57, v15
  s_mov_b32 exec_lo, 0x00ff00ff
  s_mov_b32 exec_hi, 0x00ff00ff
  ds_write_b32 v15, v16 offset:0
  ds_write_b32 v15, v17 offset:32
  ds_write_b32 v15, v18 offset:64
  ds_write_b32 v15, v19 offset:96
  s_mov_b32 exec_lo, 0
  s_mov_b32 exec_hi, 0x80000000
  v_mov_b32 v13, v14
  v_mov_b32 v15, s57
  ds_write_b64 v15, v[12:13] offset:512
  s_mov_b64 exec, -1
  v_mov_b32 v12, 0xf149f2ca
  v_mov_b32 v13, 0
  v_mov_b32 v16, 0
  v_mov_b32 v17, 0
  v_mov_b32 v18, 0
  v_mov_b32 v19, 0
  v_bfe_u32 v14, v0, 2, 2
  v_lshrrev_b32 v15, 4, v0
  v_lshl_add_u32 v14, v15, 2, v14
  v_lshlrev_b32 v14, 4, v14
  v_add_u32 v14, 148736, v14
  ds_read_b128 v[28:31], v14
  v_and_b32 v15, 3, v0
  s_waitcnt lgkmcnt(0)
  v_cmp_eq_u32 vcc, 0, v15
  s_nop 1
  v_cndmask_b32 v40, 0, v28, vcc
  v_cndmask_b32 v41, 0, v29, vcc
  v_cndmask_b32 v42, 0, v30, vcc
  v_cndmask_b32 v43, 0, v31, vcc
  v_cmp_eq_u32 vcc, 1, v15
  s_nop 1
  v_cndmask_b32 v44, 0, v28, vcc
  v_cndmask_b32 v45, 0, v29, vcc
  v_cndmask_b32 v46, 0, v30, vcc
  v_cndmask_b32 v47, 0, v31, vcc
  v_cmp_eq_u32 vcc, 2, v15
  s_nop 1
  v_cndmask_b32 v48, 0, v28, vcc
  v_cndmask_b32 v49, 0, v29, vcc
  v_cndmask_b32 v50, 0, v30, vcc
  v_cndmask_b32 v51, 0, v31, vcc
  v_cmp_eq_u32 vcc, 3, v15
  s_nop 1
  v_cndmask_b32 v52, 0, v28, vcc
  v_cndmask_b32 v53, 0, v29, vcc
  v_cndmask_b32 v54, 0, v30, vcc
  v_cndmask_b32 v55, 0, v31, vcc
  s_mov_b32 s59, 1
  s_branch L_swr0
L_stop1:
  s_mov_b32 s64, 1
  s_branch L_pos0
L_dr1:
  s_sub_u32 s64, s64, 1
  s_cmp_eq_u32 s64, 0
  s_cbranch_scc1 L_sdone
  s_branch L_pos0
L_sw1:
  s_lshl_b32 s57, s31, 1
  s_add_u32 s57, s57, 0
  s_mul_i32 s57, s57, 544
  s_add_u32 s57, s57, 148992
  s_nop 1
  v_add_f32_dpp v14, v13, v13 row_ror:8 row_mask:0xf bank_mask:0xf
  s_nop 1
  v_add_f32_dpp v14, v14, v14 row_ror:4 row_mask:0xf bank_mask:0xf
  s_nop 1
  v_add_f32_dpp v14, v14, v14 row_ror:2 row_mask:0xf bank_mask:0xf
  s_nop 1
  v_add_f32_dpp v14, v14, v14 row_ror:1 row_mask:0xf bank_mask:0xf
  s_nop 1
  v_add_f32_dpp v14, v14, v14 row_bcast:15 row_mask:0xa bank_mask:0xf
  s_nop 1
  v_add_f32_dpp v14, v14, v14 row_bcast:31 row_mask:0xc bank_mask:0xf
  v_lshrrev_b32 v15, 4, v0
  v_lshlrev_b32 v15, 7, v15
  v_and_b32 v1, 15, v0
  v_lshl_add_u32 v15, v1, 2, v15
  v_add_u32 v15, s57, v15
  s_mov_b32 exec_lo, 0x00ff00ff
  s_mov_b32 exec_hi, 0x00ff00ff
  ds_write_b32 v15, v16 offset:0
  ds_write_b32 v15, v17 offset:32
  ds_write_b32 v15, v18 offset:64
  ds_write_b32 v15, v19 offset:96
  s_mov_b32 exec_lo, 0
  s_mov_b32 exec_hi, 0x80000000
  v_mov_b32 v13, v14
  v_mov_b32 v15, s57
  ds_write_b64 v15, v[12:13] offset:512
  s_mov_b64 exec, -1
  v_mov_b32 v12, 0xf149f2ca
  v_mov_b32 v13, 0
  v_mov_b32 v16, 0
  v_mov_b32 v17, 0
  v_mov_b32 v18, 0
  v_mov_b32 v19, 0
  v_bfe_u32 v14, v0, 2, 2
  v_lshrrev_b32 v15, 4, v0
  v_lshl_add_u32 v14, v15, 2, v14
  v_lshlrev_b32 v14, 4, v14
  v_add_u32 v14, 148736, v14
  ds_read_b128 v[28:31], v14
  v_and_b32 v15, 3, v0
  s_waitcnt lgkmcnt(0)
  v_cmp_eq_u32 vcc, 0, v15
  s_nop 1
  v_cndmask_b32 v40, 0, v28, vcc
  v_cndmask_b32 v41, 0, v29, vcc
  v_cndmask_b32 v42, 0, v30, vcc
  v_cndmask_b32 v43, 0, v31, vcc
  v_cmp_eq_u32 vcc, 1, v15
  s_nop 1
  v_cndmask_b32 v44, 0, v28, vcc
  v_cndmask_b32 v45, 0, v29, vcc
  v_cndmask_b32 v46, 0, v30, vcc
  v_cndmask_b32 v47, 0, v31, vcc
  v_cmp_eq_u32 vcc, 2, v15
  s_nop 1
  v_cndmask_b32 v48, 0, v28, vcc
  v_cndmask_b32 v49, 0, v29, vcc
  v_cndmask_b32 v50, 0, v30, vcc
  v_cndmask_b32 v51, 0, v31, vcc
  v_cmp_eq_u32 vcc, 3, v15
  s_nop 1
  v_cndmask_b32 v52, 0, v28, vcc
  v_cndmask_b32 v53, 0, v29, vcc
  v_cndmask_b32 v54, 0, v30, vcc
  v_cndmask_b32 v55, 0, v31, vcc
  s_mov_b32 s59, 1
  s_branch L_swr1
L_sdone:
  s_nop 7
  s_lshl_b32 s57, s31, 1
  s_add_u32 s57, s57, s59
  s_mul_i32 s57, s57, 544
  s_add_u32 s57, s57, 148992
  s_nop 1
  v_add_f32_dpp v14, v13, v13 row_ror:8 row_mask:0xf bank_mask:0xf
  s_nop 1
  v_add_f32_dpp v14, v14, v14 row_ror:4 row_mask:0xf bank_mask:0xf
  s_nop 1
  v_add_f32_dpp v14, v14, v14 row_ror:2 row_mask:0xf bank_mask:0xf
  s_nop 1
  v_add_f32_dpp v14, v14, v14 row_ror:1 row_mask:0xf bank_mask:0xf
  s_nop 1
  v_add_f32_dpp v14, v14, v14 row_bcast:15 row_mask:0xa bank_mask:0xf
  s_nop 1
  v_add_f32_dpp v14, v14, v14 row_bcast:31 row_mask:0xc bank_mask:0xf
  v_lshrrev_b32 v15, 4, v0
  v_lshlrev_b32 v15, 7, v15
  v_and_b32 v1, 15, v0
  v_lshl_add_u32 v15, v1, 2, v15
  v_add_u32 v15, s57, v15
  s_mov_b32 exec_lo, 0x00ff00ff
  s_mov_b32 exec_hi, 0x00ff00ff
  ds_write_b32 v15, v16 offset:0
  ds_write_b32 v15, v17 offset:32
  ds_write_b32 v15, v18 offset:64
  ds_write_b32 v15, v19 offset:96
  s_mov_b32 exec_lo, 0
  s_mov_b32 exec_hi, 0x80000000
  v_mov_b32 v13, v14
  v_mov_b32 v15, s57
  ds_write_b64 v15, v[12:13] offset:512
  s_mov_b64 exec, -1
  s_cmp_eq_u32 s59, 1
  s_cbranch_scc1 L_ssaved
  v_mov_b32 v12, 0xf149f2ca
  v_mov_b32 v13, 0
  v_mov_b32 v16, 0
  v_mov_b32 v17, 0
  v_mov_b32 v18, 0
  v_mov_b32 v19, 0
  s_nop 1
  s_lshl_b32 s57, s31, 1
  s_add_u32 s57, s57, 1
  s_mul_i32 s57, s57, 544
  s_add_u32 s57, s57, 148992
  s_nop 1
  v_add_f32_dpp v14, v13, v13 row_ror:8 row_mask:0xf bank_mask:0xf
  s_nop 1
  v_add_f32_dpp v14, v14, v14 row_ror:4 row_mask:0xf bank_mask:0xf
  s_nop 1
  v_add_f32_dpp v14, v14, v14 row_ror:2 row_mask:0xf bank_mask:0xf
  s_nop 1
  v_add_f32_dpp v14, v14, v14 row_ror:1 row_mask:0xf bank_mask:0xf
  s_nop 1
  v_add_f32_dpp v14, v14, v14 row_bcast:15 row_mask:0xa bank_mask:0xf
  s_nop 1
  v_add_f32_dpp v14, v14, v14 row_bcast:31 row_mask:0xc bank_mask:0xf
  v_lshrrev_b32 v15, 4, v0
  v_lshlrev_b32 v15, 7, v15
  v_and_b32 v1, 15, v0
  v_lshl_add_u32 v15, v1, 2, v15
  v_add_u32 v15, s57, v15
  s_mov_b32 exec_lo, 0x00ff00ff
  s_mov_b32 exec_hi, 0x00ff00ff
  ds_write_b32 v15, v16 offset:0
  ds_write_b32 v15, v17 offset:32
  ds_write_b32 v15, v18 offset:64
  ds_write_b32 v15, v19 offset:96
  s_mov_b32 exec_lo, 0
  s_mov_b32 exec_hi, 0x80000000
  v_mov_b32 v13, v14
  v_mov_b32 v15, s57
  ds_write_b64 v15, v[12:13] offset:512
  s_mov_b64 exec, -1
L_ssaved:
  s_waitcnt lgkmcnt(0)
  s_barrier
  s_branch L_tail
L_help:
  s_cmp_eq_u32 s95, 1
  s_cbranch_scc1 L_hA
  s_waitcnt lgkmcnt(0)
  s_add_u32 s30, s30, 0x9e3779b9
  s_cmp_eq_u32 s31, 5
  s_cbranch_scc1 L_hp5
  s_barrier
  s_barrier
  s_barrier
  s_barrier
  s_branch L_nob1b
L_hp5:
  s_mov_b32 s40, s6
  s_and_b32 s41, s7, 0xffff
  s_mov_b32 s42, 0x10000000
  s_mov_b32 s43, 0x20000
  s_mov_b32 s44, s8
  s_and_b32 s45, s9, 0xffff
  s_mov_b32 s46, 0x10000000
  s_mov_b32 s47, 0x20000
  v_bfe_u32 v1, v0, 2, 2
  v_lshlrev_b32 v2, 8, v1
  v_and_b32 v1, 3, v0
  v_lshl_add_u32 v2, v1, 4, v2
  v_lshrrev_b32 v1, 4, v0
  v_lshl_add_u32 v2, v1, 6, v2
  v_lshlrev_b32 v4, 4, v0
  s_mov_b32 s65, 0
  s_barrier
  v_lshlrev_b32 v9, 4, v0
  s_lshl_b32 s57, s32, 13
  s_add_u32 s57, s57, 2129920
  s_add_u32 s58, s57, 4096
  s_mov_b32 s56, 60000
L_prd_3:
  buffer_load_dwordx4 v[64:67], v9, s[36:39], s57 offen sc1
  buffer_load_dwordx4 v[68:71], v9, s[36:39], s57 offen offset:1024 sc1
  buffer_load_dwordx4 v[72:75], v9, s[36:39], s57 offen offset:2048 sc1
  buffer_load_dwordx4 v[76:79], v9, s[36:39], s57 offen offset:3072 sc1
  buffer_load_dwordx4 v[80:83], v9, s[36:39], s58 offen sc1
  buffer_load_dwordx4 v[84:87], v9, s[36:39], s58 offen offset:1024 sc1
  buffer_load_dwordx4 v[88:91], v9, s[36:39], s58 offen offset:2048 sc1
  buffer_load_dwordx4 v[92:95], v9, s[36:39], s58 offen offset:3072 sc1
  s_lshr_b32 s52, s65, 2
  s_lshl_b32 s52, s52, 4
  s_and_b32 s53, s65, 3
  s_add_u32 s52, s52, s53
  s_lshr_b32 s53, s33, 1
  s_lshl_b32 s53, s53, 2
  s_add_u32 s52, s52, s53
  s_add_u32 s52, s52, 144
  s_lshl_b32 s52, s52, 13
  s_lshl_b32 s53, s32, 22
  s_add_u32 s52, s52, s53
  s_lshl_b32 s64, s65, 14
  s_mov_b32 s59, s52
  s_mov_b32 m0, s64
  s_add_u32 s64, s64, 1024
  buffer_load_dwordx4 v2, s[40:43], s59 offen nt lds
  s_add_u32 s59, s59, 1024
  s_mov_b32 m0, s64
  s_add_u32 s64, s64, 1024
  buffer_load_dwordx4 v2, s[40:43], s59 offen nt lds
  s_add_u32 s59, s59, 1024
  s_mov_b32 m0, s64
  s_add_u32 s64, s64, 1024
  buffer_load_dwordx4 v2, s[40:43], s59 offen nt lds
  s_add_u32 s59, s59, 1024
  s_mov_b32 m0, s64
  s_add_u32 s64, s64, 1024
  buffer_load_dwordx4 v2, s[40:43], s59 offen nt lds
  s_add_u32 s59, s59, 1024
  s_mov_b32 m0, s64
  s_add_u32 s64, s64, 1024
  buffer_load_dwordx4 v2, s[40:43], s59 offen nt lds
  s_add_u32 s59, s59, 1024
  s_mov_b32 m0, s64
  s_add_u32 s64, s64, 1024
  buffer_load_dwordx4 v2, s[40:43], s59 offen nt lds
  s_add_u32 s59, s59, 1024
  s_mov_b32 m0, s64
  s_add_u32 s64, s64, 1024
  buffer_load_dwordx4 v2, s[40:43], s59 offen nt lds
  s_add_u32 s59, s59, 1024
  s_mov_b32 m0, s64
  s_add_u32 s64, s64, 1024
  buffer_load_dwordx4 v2, s[40:43], s59 offen nt lds
  s_add_u32 s59, s59, 1024
  s_mov_b32 s59, s52
  s_mov_b32 m0, s64
  s_add_u32 s64, s64, 1024
  buffer_load_dwordx4 v4, s[44:47], s59 offen nt lds
  s_add_u32 s59, s59, 1024
  s_mov_b32 m0, s64
  s_add_u32 s64, s64, 1024
  buffer_load_dwordx4 v4, s[44:47], s59 offen nt lds
  s_add_u32 s59, s59, 1024
  s_mov_b32 m0, s64
  s_add_u32 s64, s64, 1024
  buffer_load_dwordx4 v4, s[44:47], s59 offen nt lds
  s_add_u32 s59, s59, 1024
  s_mov_b32 m0, s64
  s_add_u32 s64, s64, 1024
  buffer_load_dwordx4 v4, s[44:47], s59 offen nt lds
  s_add_u32 s59, s59, 1024
  s_mov_b32 m0, s64
  s_add_u32 s64, s64, 1024
  buffer_load_dwordx4 v4, s[44:47], s59 offen nt lds
  s_add_u32 s59, s59, 1024
  s_mov_b32 m0, s64
  s_add_u32 s64, s64, 1024
  buffer_load_dwordx4 v4, s[44:47], s59 offen nt lds
  s_add_u32 s59, s59, 1024
  s_mov_b32 m0, s64
  s_add_u32 s64, s64, 1024
  buffer_load_dwordx4 v4, s[44:47], s59 offen nt lds
  s_add_u32 s59, s59, 1024
  s_mov_b32 m0, s64
  s_add_u32 s64, s64, 1024
  buffer_load_dwordx4 v4, s[44:47], s59 offen nt lds
  s_add_u32 s59, s59, 1024
  s_add_u32 s65, s65, 1
  s_waitcnt vmcnt(16)
  v_max3_u32 v10, s30, v65, v67
  v_min3_u32 v11, s30, v65, v67
  v_max3_u32 v10, v10, v69, v71
  v_min3_u32 v11, v11, v69, v71
  v_max3_u32 v10, v10, v73, v75
  v_min3_u32 v11, v11, v73, v75
  v_max3_u32 v10, v10, v77, v79
  v_min3_u32 v11, v11, v77, v79
  v_max3_u32 v10, v10, v81, v83
  v_min3_u32 v11, v11, v81, v83
  v_max3_u32 v10, v10, v85, v87
  v_min3_u32 v11, v11, v85, v87
  v_max3_u32 v10, v10, v89, v91
  v_min3_u32 v11, v11, v89, v91
  v_max3_u32 v10, v10, v93, v95
  v_min3_u32 v11, v11, v93, v95
  v_xor_b32 v10, v10, v11
  v_cmp_ne_u32 vcc, 0, v10
  s_and_b64 vcc, exec, vcc
  s_cbranch_vccz L_polld_2
  s_cmp_lt_u32 s65, 8
  s_cbranch_scc1 L_prd_3
L_poll_1:
  buffer_load_dwordx4 v[64:67], v9, s[36:39], s57 offen sc1
  buffer_load_dwordx4 v[68:71], v9, s[36:39], s57 offen offset:1024 sc1
  buffer_load_dwordx4 v[72:75], v9, s[36:39], s57 offen offset:2048 sc1
  buffer_load_dwordx4 v[76:79], v9, s[36:39], s57 offen offset:3072 sc1
  buffer_load_dwordx4 v[80:83], v9, s[36:39], s58 offen sc1
  buffer_load_dwordx4 v[84:87], v9, s[36:39], s58 offen offset:1024 sc1
  buffer_load_dwordx4 v[88:91], v9, s[36:39], s58 offen offset:2048 sc1
  buffer_load_dwordx4 v[92:95], v9, s[36:39], s58 offen offset:3072 sc1
  s_waitcnt vmcnt(0)
  v_max3_u32 v10, s30, v65, v67
  v_min3_u32 v11, s30, v65, v67
  v_max3_u32 v10, v10, v69, v71
  v_min3_u32 v11, v11, v69, v71
  v_max3_u32 v10, v10, v73, v75
  v_min3_u32 v11, v11, v73, v75
  v_max3_u32 v10, v10, v77, v79
  v_min3_u32 v11, v11, v77, v79
  v_max3_u32 v10, v10, v81, v83
  v_min3_u32 v11, v11, v81, v83
  v_max3_u32 v10, v10, v85, v87
  v_min3_u32 v11, v11, v85, v87
  v_max3_u32 v10, v10, v89, v91
  v_min3_u32 v11, v11, v89, v91
  v_max3_u32 v10, v10, v93, v95
  v_min3_u32 v11, v11, v93, v95
  v_xor_b32 v10, v10, v11
  v_cmp_ne_u32 vcc, 0, v10
  s_sub_u32 s56, s56, 1
  s_cmp_eq_u32 s56, 0
  s_cbranch_scc1 L_polld_2
  s_and_b64 vcc, exec, vcc
  s_cbranch_vccnz L_poll_1
L_polld_2:
  v_lshlrev_b32 v3, 1, v0
  v_add_u32 v3, 148480, v3
  v_add_f32 v64, v64, v72
  v_add_f32 v80, v80, v88
  v_add_f32 v66, v66, v74
  v_add_f32 v82, v82, v90
  v_add_f32 v64, v64, v80
  v_add_f32 v66, v66, v82
  v_cvt_pk_bf16_f32 v64, v64, v66
  ds_write_b16 v3, v64 offset:0
  ds_write_b16_d16_hi v3, v64 offset:256
  v_add_f32 v68, v68, v76
  v_add_f32 v84, v84, v92
  v_add_f32 v70, v70, v78
  v_add_f32 v86, v86, v94
  v_add_f32 v68, v68, v84
  v_add_f32 v70, v70, v86
  v_cvt_pk_bf16_f32 v68, v68, v70
  ds_write_b16 v3, v68 offset:128
  ds_write_b16_d16_hi v3, v68 offset:384
  s_waitcnt lgkmcnt(0)
  s_barrier
L_hp5r:
  s_cmp_ge_u32 s65, 8
  s_cbranch_scc1 L_hp5d
  s_lshr_b32 s52, s65, 2
  s_lshl_b32 s52, s52, 4
  s_and_b32 s53, s65, 3
  s_add_u32 s52, s52, s53
  s_lshr_b32 s53, s33, 1
  s_lshl_b32 s53, s53, 2
  s_add_u32 s52, s52, s53
  s_add_u32 s52, s52, 144
  s_lshl_b32 s52, s52, 13
  s_lshl_b32 s53, s32, 22
  s_add_u32 s52, s52, s53
  s_lshl_b32 s64, s65, 14
  s_mov_b32 s59, s52
  s_mov_b32 m0, s64
  s_add_u32 s64, s64, 1024
  buffer_load_dwordx4 v2, s[40:43], s59 offen nt lds
  s_add_u32 s59, s59, 1024
  s_mov_b32 m0, s64
  s_add_u32 s64, s64, 1024
  buffer_load_dwordx4 v2, s[40:43], s59 offen nt lds
  s_add_u32 s59, s59, 1024
  s_mov_b32 m0, s64
  s_add_u32 s64, s64, 1024
  buffer_load_dwordx4 v2, s[40:43], s59 offen nt lds
  s_add_u32 s59, s59, 1024
  s_mov_b32 m0, s64
  s_add_u32 s64, s64, 1024
  buffer_load_dwordx4 v2, s[40:43], s59 offen nt lds
  s_add_u32 s59, s59, 1024
  s_mov_b32 m0, s64
  s_add_u32 s64, s64, 1024
  buffer_load_dwordx4 v2, s[40:43], s59 offen nt lds
  s_add_u32 s59, s59, 1024
  s_mov_b32 m0, s64
  s_add_u32 s64, s64, 1024
  buffer_load_dwordx4 v2, s[40:43], s59 offen nt lds
  s_add_u32 s59, s59, 1024
  s_mov_b32 m0, s64
  s_add_u32 s64, s64, 1024
  buffer_load_dwordx4 v2, s[40:43], s59 offen nt lds
  s_add_u32 s59, s59, 1024
  s_mov_b32 m0, s64
  s_add_u32 s64, s64, 1024
  buffer_load_dwordx4 v2, s[40:43], s59 offen nt lds
  s_add_u32 s59, s59, 1024
  s_mov_b32 s59, s52
  s_mov_b32 m0, s64
  s_add_u32 s64, s64, 1024
  buffer_load_dwordx4 v4, s[44:47], s59 offen nt lds
  s_add_u32 s59, s59, 1024
  s_mov_b32 m0, s64
  s_add_u32 s64, s64, 1024
  buffer_load_dwordx4 v4, s[44:47], s59 offen nt lds
  s_add_u32 s59, s59, 1024
  s_mov_b32 m0, s64
  s_add_u32 s64, s64, 1024
  buffer_load_dwordx4 v4, s[44:47], s59 offen nt lds
  s_add_u32 s59, s59, 1024
  s_mov_b32 m0, s64
  s_add_u32 s64, s64, 1024
  buffer_load_dwordx4 v4, s[44:47], s59 offen nt lds
  s_add_u32 s59, s59, 1024
  s_mov_b32 m0, s64
  s_add_u32 s64, s64, 1024
  buffer_load_dwordx4 v4, s[44:47], s59 offen nt lds
  s_add_u32 s59, s59, 1024
  s_mov_b32 m0, s64
  s_add_u32 s64, s64, 1024
  buffer_load_dwordx4 v4, s[44:47], s59 offen nt lds
  s_add_u32 s59, s59, 1024
  s_mov_b32 m0, s64
  s_add_u32 s64, s64, 1024
  buffer_load_dwordx4 v4, s[44:47], s59 offen nt lds
  s_add_u32 s59, s59, 1024
  s_mov_b32 m0, s64
  s_add_u32 s64, s64, 1024
  buffer_load_dwordx4 v4, s[44:47], s59 offen nt lds
  s_add_u32 s59, s59, 1024
  s_add_u32 s65, s65, 1
  s_branch L_hp5r
L_hp5d:
  s_waitcnt vmcnt(0)
  s_barrier
  s_barrier
  s_branch L_nob1b
L_hA:
  s_cmp_eq_u32 s31, 5
  s_cbranch_scc1 L_hq
  s_cmp_eq_u32 s31, 6
  s_cbranch_scc1 L_hq6
  s_cmp_eq_u32 s31, 4
  s_cbranch_scc0 L_hb0
  s_cmp_lt_u32 s96, 80
  s_cbranch_scc0 L_hb0
  s_mov_b32 s65, s96
  s_mov_b32 s40, s24
  s_and_b32 s41, s25, 0xffff
  s_mov_b32 s42, 0x4b0000
  s_mov_b32 s43, 0x20000
  s_mov_b32 s48, s22
  s_and_b32 s49, s23, 0xffff
  s_mov_b32 s50, 0xa00
  s_mov_b32 s51, 0x20000
  s_and_b32 s66, s65, 3
  s_lshr_b32 s67, s65, 2
  v_and_b32 v1, 31, v0
  v_lshrrev_b32 v3, 5, v0
  v_mul_u32_u24 v8, 1280, v3
  v_lshl_add_u32 v8, v1, 1, v8
  s_mul_i32 s57, s66, 320
  buffer_load_ushort v16, v8, s[48:51], s57 offen offset:0
  buffer_load_ushort v17, v8, s[48:51], s57 offen offset:64
  buffer_load_ushort v18, v8, s[48:51], s57 offen offset:128
  buffer_load_ushort v19, v8, s[48:51], s57 offen offset:192
  buffer_load_ushort v20, v8, s[48:51], s57 offen offset:256
  s_mul_i32 s52, s66, 1228800
  s_lshl_b32 s57, s67, 7
  s_add_u32 s52, s52, s57
  v_lshrrev_b32 v1, 3, v0
  v_mul_u32_u24 v2, 7680, v1
  v_and_b32 v1, 7, v0
  v_lshl_add_u32 v2, v1, 4, v2
  s_mov_b32 m0, 40960
  s_nop 0
  buffer_load_dwordx4 v2, s[40:43], s52 offen nt lds
  s_mov_b32 m0, 41984
  s_add_u32 s52, s52, 61440
  buffer_load_dwordx4 v2, s[40:43], s52 offen nt lds
  s_mov_b32 m0, 43008
  s_add_u32 s52, s52, 61440
  buffer_load_dwordx4 v2, s[40:43], s52 offen nt lds
  s_mov_b32 m0, 44032
  s_add_u32 s52, s52, 61440
  buffer_load_dwordx4 v2, s[40:43], s52 offen nt lds
  s_mov_b32 m0, 45056
  s_add_u32 s52, s52, 61440
  buffer_load_dwordx4 v2, s[40:43], s52 offen nt lds
  s_mov_b32 m0, 46080
  s_add_u32 s52, s52, 61440
  buffer_load_dwordx4 v2, s[40:43], s52 offen nt lds
  s_mov_b32 m0, 47104
  s_add_u32 s52, s52, 61440
  buffer_load_dwordx4 v2, s[40:43], s52 offen nt lds
  s_mov_b32 m0, 48128
  s_add_u32 s52, s52, 61440
  buffer_load_dwordx4 v2, s[40:43], s52 offen nt lds
  s_mov_b32 m0, 49152
  s_add_u32 s52, s52, 61440
  buffer_load_dwordx4 v2, s[40:43], s52 offen nt lds
  s_mov_b32 m0, 50176
  s_add_u32 s52, s52, 61440
  buffer_load_dwordx4 v2, s[40:43], s52 offen nt lds
  s_mov_b32 m0, 51200
  s_add_u32 s52, s52, 61440
  buffer_load_dwordx4 v2, s[40:43], s52 offen nt lds
  s_mov_b32 m0, 52224
  s_add_u32 s52, s52, 61440
  buffer_load_dwordx4 v2, s[40:43], s52 offen nt lds
  s_mov_b32 m0, 53248
  s_add_u32 s52, s52, 61440
  buffer_load_dwordx4 v2, s[40:43], s52 offen nt lds
  s_mov_b32 m0, 54272
  s_add_u32 s52, s52, 61440
  buffer_load_dwordx4 v2, s[40:43], s52 offen nt lds
  s_mov_b32 m0, 55296
  s_add_u32 s52, s52, 61440
  buffer_load_dwordx4 v2, s[40:43], s52 offen nt lds
  s_mov_b32 m0, 56320
  s_add_u32 s52, s52, 61440
  buffer_load_dwordx4 v2, s[40:43], s52 offen nt lds
  s_mov_b32 m0, 57344
  s_add_u32 s52, s52, 61440
  buffer_load_dwordx4 v2, s[40:43], s52 offen nt lds
  s_mov_b32 m0, 58368
  s_add_u32 s52, s52, 61440
  buffer_load_dwordx4 v2, s[40:43], s52 offen nt lds
  s_mov_b32 m0, 59392
  s_add_u32 s52, s52, 61440
  buffer_load_dwordx4 v2, s[40:43], s52 offen nt lds
  s_mov_b32 m0, 60416
  s_add_u32 s52, s52, 61440
  buffer_load_dwordx4 v2, s[40:43], s52 offen nt lds
  s_waitcnt lgkmcnt(0)
  s_add_u32 s30, s30, 0x9e3779b9
  v_mul_u32_u24 v8, 320, v3
  v_and_b32 v1, 31, v0
  v_lshl_add_u32 v8, v1, 1, v8
  v_add_u32 v8, 153344, v8
  s_waitcnt vmcnt(20)
  v_lshlrev_b32 v16, 16, v16
  v_mul_f32 v10, 0xbfb8aa3b, v16
  v_exp_f32 v10, v10
  s_nop 0
  v_add_f32 v10, 1.0, v10
  v_rcp_f32 v10, v10
  s_nop 0
  v_mul_f32 v16, v16, v10
  v_cvt_pk_bf16_f32 v16, v16, v16
  ds_write_b16 v8, v16 offset:0
  v_lshlrev_b32 v17, 16, v17
  v_mul_f32 v10, 0xbfb8aa3b, v17
  v_exp_f32 v10, v10
  s_nop 0
  v_add_f32 v10, 1.0, v10
  v_rcp_f32 v10, v10
  s_nop 0
  v_mul_f32 v17, v17, v10
  v_cvt_pk_bf16_f32 v17, v17, v17
  ds_write_b16 v8, v17 offset:64
  v_lshlrev_b32 v18, 16, v18
  v_mul_f32 v10, 0xbfb8aa3b, v18
  v_exp_f32 v10, v10
  s_nop 0
  v_add_f32 v10, 1.0, v10
  v_rcp_f32 v10, v10
  s_nop 0
  v_mul_f32 v18, v18, v10
  v_cvt_pk_bf16_f32 v18, v18, v18
  ds_write_b16 v8, v18 offset:128
  v_lshlrev_b32 v19, 16, v19
  v_mul_f32 v10, 0xbfb8aa3b, v19
  v_exp_f32 v10, v10
  s_nop 0
  v_add_f32 v10, 1.0, v10
  v_rcp_f32 v10, v10
  s_nop 0
  v_mul_f32 v19, v19, v10
  v_cvt_pk_bf16_f32 v19, v19, v19
  ds_write_b16 v8, v19 offset:192
  v_lshlrev_b32 v20, 16, v20
  v_mul_f32 v10, 0xbfb8aa3b, v20
  v_exp_f32 v10, v10
  s_nop 0
  v_add_f32 v10, 1.0, v10
  v_rcp_f32 v10, v10
  s_nop 0
  v_mul_f32 v20, v20, v10
  v_cvt_pk_bf16_f32 v20, v20, v20
  ds_write_b16 v8, v20 offset:256
  v_and_b32 v1, 1, v0
  v_mul_u32_u24 v6, 320, v1
  v_lshrrev_b32 v1, 4, v0
  v_lshl_add_u32 v6, v1, 4, v6
  v_add_u32 v6, 153344, v6
  v_lshlrev_b32 v7, 3, v1
  v_bfe_u32 v1, v0, 2, 2
  v_add_u32 v7, v7, v1
  v_mul_u32_u24 v7, 128, v7
  v_and_b32 v1, 3, v0
  v_lshl_add_u32 v7, v1, 3, v7
  v_add_u32 v7, 40960, v7
  s_waitcnt vmcnt(0) lgkmcnt(0)
  ds_read_b128 v[40:43], v6 offset:0
  ds_read_b64_tr_b16 v[44:45], v7 offset:0
  ds_read_b64_tr_b16 v[46:47], v7 offset:512
  ds_read_b64_tr_b16 v[48:49], v7 offset:32
  ds_read_b64_tr_b16 v[50:51], v7 offset:544
  ds_read_b64_tr_b16 v[52:53], v7 offset:64
  ds_read_b64_tr_b16 v[54:55], v7 offset:576
  ds_read_b64_tr_b16 v[56:57], v7 offset:96
  ds_read_b64_tr_b16 v[58:59], v7 offset:608
  ds_read_b128 v[60:63], v6 offset:64
  ds_read_b64_tr_b16 v[64:65], v7 offset:4096
  ds_read_b64_tr_b16 v[66:67], v7 offset:4608
  ds_read_b64_tr_b16 v[68:69], v7 offset:4128
  ds_read_b64_tr_b16 v[70:71], v7 offset:4640
  ds_read_b64_tr_b16 v[72:73], v7 offset:4160
  ds_read_b64_tr_b16 v[74:75], v7 offset:4672
  ds_read_b64_tr_b16 v[76:77], v7 offset:4192
  ds_read_b64_tr_b16 v[78:79], v7 offset:4704
  ds_read_b128 v[80:83], v6 offset:128
  ds_read_b64_tr_b16 v[84:85], v7 offset:8192
  ds_read_b64_tr_b16 v[86:87], v7 offset:8704
  ds_read_b64_tr_b16 v[88:89], v7 offset:8224
  ds_read_b64_tr_b16 v[90:91], v7 offset:8736
  ds_read_b64_tr_b16 v[92:93], v7 offset:8256
  ds_read_b64_tr_b16 v[94:95], v7 offset:8768
  ds_read_b64_tr_b16 v[96:97], v7 offset:8288
  ds_read_b64_tr_b16 v[98:99], v7 offset:8800
  ds_read_b128 v[100:103], v6 offset:192
  ds_read_b64_tr_b16 v[104:105], v7 offset:12288
  ds_read_b64_tr_b16 v[106:107], v7 offset:12800
  ds_read_b64_tr_b16 v[108:109], v7 offset:12320
  ds_read_b64_tr_b16 v[110:111], v7 offset:12832
  ds_read_b64_tr_b16 v[112:113], v7 offset:12352
  ds_read_b64_tr_b16 v[114:115], v7 offset:12864
  ds_read_b64_tr_b16 v[116:117], v7 offset:12384
  ds_read_b64_tr_b16 v[118:119], v7 offset:12896
  ds_read_b128 v[120:123], v6 offset:256
  ds_read_b64_tr_b16 v[124:125], v7 offset:16384
  ds_read_b64_tr_b16 v[126:127], v7 offset:16896
  ds_read_b64_tr_b16 v[128:129], v7 offset:16416
  ds_read_b64_tr_b16 v[130:131], v7 offset:16928
  ds_read_b64_tr_b16 v[132:133], v7 offset:16448
  ds_read_b64_tr_b16 v[134:135], v7 offset:16960
  ds_read_b64_tr_b16 v[136:137], v7 offset:16480
  ds_read_b64_tr_b16 v[138:139], v7 offset:16992
  s_waitcnt lgkmcnt(15)
  v_mfma_f32_16x16x32_bf16 v[24:27], v[40:43], v[44:47], 0
  v_mfma_f32_16x16x32_bf16 v[28:31], v[40:43], v[48:51], 0
  v_mfma_f32_16x16x32_bf16 v[32:35], v[40:43], v[52:55], 0
  v_mfma_f32_16x16x32_bf16 v[36:39], v[40:43], v[56:59], 0
  s_waitcnt lgkmcnt(15)
  v_mfma_f32_16x16x32_bf16 v[24:27], v[60:63], v[64:67], v[24:27]
  v_mfma_f32_16x16x32_bf16 v[28:31], v[60:63], v[68:71], v[28:31]
  v_mfma_f32_16x16x32_bf16 v[32:35], v[60:63], v[72:75], v[32:35]
  v_mfma_f32_16x16x32_bf16 v[36:39], v[60:63], v[76:79], v[36:39]
  s_waitcnt lgkmcnt(15)
  v_mfma_f32_16x16x32_bf16 v[24:27], v[80:83], v[84:87], v[24:27]
  v_mfma_f32_16x16x32_bf16 v[28:31], v[80:83], v[88:91], v[28:31]
  v_mfma_f32_16x16x32_bf16 v[32:35], v[80:83], v[92:95], v[32:35]
  v_mfma_f32_16x16x32_bf16 v[36:39], v[80:83], v[96:99], v[36:39]
  s_waitcnt lgkmcnt(9)
  v_mfma_f32_16x16x32_bf16 v[24:27], v[100:103], v[104:107], v[24:27]
  v_mfma_f32_16x16x32_bf16 v[28:31], v[100:103], v[108:111], v[28:31]
  v_mfma_f32_16x16x32_bf16 v[32:35], v[100:103], v[112:115], v[32:35]
  v_mfma_f32_16x16x32_bf16 v[36:39], v[100:103], v[116:119], v[36:39]
  s_waitcnt lgkmcnt(0)
  v_mfma_f32_16x16x32_bf16 v[24:27], v[120:123], v[124:127], v[24:27]
  v_mfma_f32_16x16x32_bf16 v[28:31], v[120:123], v[128:131], v[28:31]
  v_mfma_f32_16x16x32_bf16 v[32:35], v[120:123], v[132:135], v[32:35]
  v_mfma_f32_16x16x32_bf16 v[36:39], v[120:123], v[136:139], v[36:39]
  s_nop 7
  s_mul_i32 s57, s66, 20480
  s_lshl_b32 s58, s67, 10
  s_add_u32 s57, s57, s58
  s_add_u32 s57, s57, 2031616
  v_lshlrev_b32 v1, 4, v0
  v_mov_b32 v200, v24
  v_mov_b32 v201, s30
  v_mov_b32 v202, v25
  v_mov_b32 v203, s30
  v_mov_b32 v204, v28
  v_mov_b32 v205, s30
  v_mov_b32 v206, v29
  v_mov_b32 v207, s30
  v_mov_b32 v208, v32
  v_mov_b32 v209, s30
  v_mov_b32 v210, v33
  v_mov_b32 v211, s30
  v_mov_b32 v212, v36
  v_mov_b32 v213, s30
  v_mov_b32 v214, v37
  v_mov_b32 v215, s30
  s_mov_b64 exec, 0xffff
  buffer_store_dwordx4 v[200:203], v1, s[36:39], s57 offen offset:0 sc1
  buffer_store_dwordx4 v[204:207], v1, s[36:39], s57 offen offset:256 sc1
  buffer_store_dwordx4 v[208:211], v1, s[36:39], s57 offen offset:512 sc1
  buffer_store_dwordx4 v[212:215], v1, s[36:39], s57 offen offset:768 sc1
  s_mov_b64 exec, -1
  s_branch L_hba
L_hq:
  s_mov_b32 s48, s4
  s_and_b32 s49, s5, 0xffff
  s_mov_b32 s50, 0xa00
  s_mov_b32 s51, 0x20000
  s_lshr_b32 s66, s33, 1
  v_lshlrev_b32 v3, 2, v0
  buffer_load_dword v16, v3, s[48:51], 0 offen offset:0
  buffer_load_dword v17, v3, s[48:51], 0 offen offset:256
  buffer_load_dword v18, v3, s[48:51], 0 offen offset:512
  buffer_load_dword v19, v3, s[48:51], 0 offen offset:768
  buffer_load_dword v20, v3, s[48:51], 0 offen offset:1024
  buffer_load_dword v21, v3, s[48:51], 0 offen offset:1280
  buffer_load_dword v22, v3, s[48:51], 0 offen offset:1536
  buffer_load_dword v23, v3, s[48:51], 0 offen offset:1792
  buffer_load_dword v24, v3, s[48:51], 0 offen offset:2048
  buffer_load_dword v25, v3, s[48:51], 0 offen offset:2304
  v_lshlrev_b32 v8, 1, v0
  s_mul_i32 s57, s66, 320
  buffer_load_ushort v26, v8, s[48:51], s57 offen offset:0
  buffer_load_ushort v28, v8, s[48:51], s57 offen offset:128
  s_mov_b32 exec_hi, 0
  buffer_load_ushort v30, v8, s[48:51], s57 offen offset:256
  s_mov_b64 exec, -1
  buffer_load_ushort v27, v8, s[48:51], s57 offen offset:1280
  buffer_load_ushort v29, v8, s[48:51], s57 offen offset:1408
  s_mov_b32 exec_hi, 0
  buffer_load_ushort v31, v8, s[48:51], s57 offen offset:1536
  s_mov_b64 exec, -1
  s_mov_b32 s40, s10
  s_and_b32 s41, s11, 0xffff
  s_mov_b32 s42, 0x500000
  s_mov_b32 s43, 0x20000
  s_sub_u32 s67, s31, 5
  s_lshr_b32 s66, s33, 1
  s_mul_i32 s52, s66, 1310720
  s_lshl_b32 s57, s32, 8
  s_add_u32 s52, s52, s57
  s_lshl_b32 s57, s67, 7
  s_add_u32 s52, s52, s57
  v_lshrrev_b32 v1, 3, v0
  v_mul_u32_u24 v2, 8192, v1
  v_and_b32 v1, 7, v0
  v_lshl_add_u32 v2, v1, 4, v2
  s_mul_i32 s53, s67, 20480
  s_add_u32 s53, s53, 0
  s_mov_b32 m0, s53
  s_add_u32 s53, s53, 1024
  buffer_load_dwordx4 v2, s[40:43], s52 offen nt lds
  s_add_u32 s52, s52, 65536
  s_mov_b32 m0, s53
  s_add_u32 s53, s53, 1024
  buffer_load_dwordx4 v2, s[40:43], s52 offen nt lds
  s_add_u32 s52, s52, 65536
  s_mov_b32 m0, s53
  s_add_u32 s53, s53, 1024
  buffer_load_dwordx4 v2, s[40:43], s52 offen nt lds
  s_add_u32 s52, s52, 65536
  s_mov_b32 m0, s53
  s_add_u32 s53, s53, 1024
  buffer_load_dwordx4 v2, s[40:43], s52 offen nt lds
  s_add_u32 s52, s52, 65536
  s_mov_b32 m0, s53
  s_add_u32 s53, s53, 1024
  buffer_load_dwordx4 v2, s[40:43], s52 offen nt lds
  s_add_u32 s52, s52, 65536
  s_mov_b32 m0, s53
  s_add_u32 s53, s53, 1024
  buffer_load_dwordx4 v2, s[40:43], s52 offen nt lds
  s_add_u32 s52, s52, 65536
  s_mov_b32 m0, s53
  s_add_u32 s53, s53, 1024
  buffer_load_dwordx4 v2, s[40:43], s52 offen nt lds
  s_add_u32 s52, s52, 65536
  s_mov_b32 m0, s53
  s_add_u32 s53, s53, 1024
  buffer_load_dwordx4 v2, s[40:43], s52 offen nt lds
  s_add_u32 s52, s52, 65536
  s_mov_b32 m0, s53
  s_add_u32 s53, s53, 1024
  buffer_load_dwordx4 v2, s[40:43], s52 offen nt lds
  s_add_u32 s52, s52, 65536
  s_mov_b32 m0, s53
  s_add_u32 s53, s53, 1024
  buffer_load_dwordx4 v2, s[40:43], s52 offen nt lds
  s_add_u32 s52, s52, 65536
  s_mov_b32 m0, s53
  s_add_u32 s53, s53, 1024
  buffer_load_dwordx4 v2, s[40:43], s52 offen nt lds
  s_add_u32 s52, s52, 65536
  s_mov_b32 m0, s53
  s_add_u32 s53, s53, 1024
  buffer_load_dwordx4 v2, s[40:43], s52 offen nt lds
  s_add_u32 s52, s52, 65536
  s_mov_b32 m0, s53
  s_add_u32 s53, s53, 1024
  buffer_load_dwordx4 v2, s[40:43], s52 offen nt lds
  s_add_u32 s52, s52, 65536
  s_mov_b32 m0, s53
  s_add_u32 s53, s53, 1024
  buffer_load_dwordx4 v2, s[40:43], s52 offen nt lds
  s_add_u32 s52, s52, 65536
  s_mov_b32 m0, s53
  s_add_u32 s53, s53, 1024
  buffer_load_dwordx4 v2, s[40:43], s52 offen nt lds
  s_add_u32 s52, s52, 65536
  s_mov_b32 m0, s53
  s_add_u32 s53, s53, 1024
  buffer_load_dwordx4 v2, s[40:43], s52 offen nt lds
  s_add_u32 s52, s52, 65536
  s_mov_b32 m0, s53
  s_add_u32 s53, s53, 1024
  buffer_load_dwordx4 v2, s[40:43], s52 offen nt lds
  s_add_u32 s52, s52, 65536
  s_mov_b32 m0, s53
  s_add_u32 s53, s53, 1024
  buffer_load_dwordx4 v2, s[40:43], s52 offen nt lds
  s_add_u32 s52, s52, 65536
  s_mov_b32 m0, s53
  s_add_u32 s53, s53, 1024
  buffer_load_dwordx4 v2, s[40:43], s52 offen nt lds
  s_add_u32 s52, s52, 65536
  s_mov_b32 m0, s53
  s_add_u32 s53, s53, 1024
  buffer_load_dwordx4 v2, s[40:43], s52 offen nt lds
  s_add_u32 s52, s52, 65536
  s_waitcnt lgkmcnt(0)
  s_add_u32 s30, s30, 0x9e3779b9
  s_cmp_lg_u32 s66, 0
  s_cbranch_scc1 L_noinit
  s_lshl_b32 s57, s32, 13
  s_add_u32 s57, s57, 65536
  v_mov_b32 v4, 48
  v_mov_b32 v1, 0
  s_mov_b64 exec, 1
  buffer_store_dword v4, v1, s[36:39], s57 offen sc1
  s_mov_b64 exec, -1
  s_waitcnt vmcnt(21)
  s_branch L_init2
L_noinit:
  s_waitcnt vmcnt(20)
L_init2:
  v_and_b32 v33, 0xffff0000, v16
  v_lshlrev_b32 v32, 16, v16
  v_and_b32 v37, 0xffff0000, v17
  v_lshlrev_b32 v36, 16, v17
  v_and_b32 v41, 0xffff0000, v18
  v_lshlrev_b32 v40, 16, v18
  v_and_b32 v45, 0xffff0000, v19
  v_lshlrev_b32 v44, 16, v19
  v_and_b32 v49, 0xffff0000, v20
  v_lshlrev_b32 v48, 16, v20
  v_and_b32 v35, 0xffff0000, v21
  v_lshlrev_b32 v34, 16, v21
  v_and_b32 v39, 0xffff0000, v22
  v_lshlrev_b32 v38, 16, v22
  v_and_b32 v43, 0xffff0000, v23
  v_lshlrev_b32 v42, 16, v23
  v_and_b32 v47, 0xffff0000, v24
  v_lshlrev_b32 v46, 16, v24
  v_and_b32 v51, 0xffff0000, v25
  v_lshlrev_b32 v50, 16, v25
  v_lshlrev_b32 v26, 16, v26
  v_lshlrev_b32 v27, 16, v27
  v_lshlrev_b32 v28, 16, v28
  v_lshlrev_b32 v29, 16, v29
  v_lshlrev_b32 v30, 16, v30
  v_lshlrev_b32 v31, 16, v31
  v_add_f32 v52, v32, v33
  v_add_f32 v52, v52, v36
  v_add_f32 v52, v52, v37
  v_add_f32 v52, v52, v40
  v_add_f32 v52, v52, v41
  v_add_f32 v52, v52, v44
  v_add_f32 v52, v52, v45
  v_add_f32 v52, v52, v48
  v_add_f32 v52, v52, v49
  s_nop 1
  v_add_f32_dpp v53, v52, v52 row_ror:8 row_mask:0xf bank_mask:0xf
  s_nop 1
  v_add_f32_dpp v53, v53, v53 row_ror:4 row_mask:0xf bank_mask:0xf
  s_nop 1
  v_add_f32_dpp v53, v53, v53 row_ror:2 row_mask:0xf bank_mask:0xf
  s_nop 1
  v_add_f32_dpp v53, v53, v53 row_ror:1 row_mask:0xf bank_mask:0xf
  s_nop 1
  v_add_f32_dpp v53, v53, v53 row_bcast:15 row_mask:0xa bank_mask:0xf
  s_nop 1
  v_add_f32_dpp v53, v53, v53 row_bcast:31 row_mask:0xc bank_mask:0xf
  s_nop 0
  v_readlane_b32 s57, v53, 63
  s_nop 1
  v_mov_b32 v52, s57
  v_mul_f32 v52, 0x3acccccd, v52
  v_sub_f32 v54, v32, v52
  v_mul_f32 v55, v54, v54
  v_sub_f32 v54, v33, v52
  v_fma_f32 v55, v54, v54, v55
  v_sub_f32 v54, v36, v52
  v_fma_f32 v55, v54, v54, v55
  v_sub_f32 v54, v37, v52
  v_fma_f32 v55, v54, v54, v55
  v_sub_f32 v54, v40, v52
  v_fma_f32 v55, v54, v54, v55
  v_sub_f32 v54, v41, v52
  v_fma_f32 v55, v54, v54, v55
  v_sub_f32 v54, v44, v52
  v_fma_f32 v55, v54, v54, v55
  v_sub_f32 v54, v45, v52
  v_fma_f32 v55, v54, v54, v55
  v_sub_f32 v54, v48, v52
  v_fma_f32 v55, v54, v54, v55
  v_sub_f32 v54, v49, v52
  v_fma_f32 v55, v54, v54, v55
  s_nop 1
  v_add_f32_dpp v53, v55, v55 row_ror:8 row_mask:0xf bank_mask:0xf
  s_nop 1
  v_add_f32_dpp v53, v53, v53 row_ror:4 row_mask:0xf bank_mask:0xf
  s_nop 1
  v_add_f32_dpp v53, v53, v53 row_ror:2 row_mask:0xf bank_mask:0xf
  s_nop 1
  v_add_f32_dpp v53, v53, v53 row_ror:1 row_mask:0xf bank_mask:0xf
  s_nop 1
  v_add_f32_dpp v53, v53, v53 row_bcast:15 row_mask:0xa bank_mask:0xf
  s_nop 1
  v_add_f32_dpp v53, v53, v53 row_bcast:31 row_mask:0xc bank_mask:0xf
  s_nop 0
  v_readlane_b32 s57, v53, 63
  s_nop 1
  v_mov_b32 v53, s57
  v_mul_f32 v53, 0x3acccccd, v53
  v_cvt_pk_bf16_f32 v54, v52, v53
  v_and_b32 v53, 0xffff0000, v54
  v_lshlrev_b32 v52, 16, v54
  v_add_f32 v53, 0x3727c5ac, v53
  v_mov_b32 v55, 0
  v_cvt_pk_bf16_f32 v54, v53, v55
  v_and_b32 v55, 0xffff0000, v54
  v_lshlrev_b32 v53, 16, v54
  v_sqrt_f32 v53, v53
  s_nop 0
  v_cvt_pk_bf16_f32 v54, v53, v55
  v_and_b32 v55, 0xffff0000, v54
  v_lshlrev_b32 v53, 16, v54
  v_rcp_f32 v53, v53
  s_nop 0
  v_sub_f32 v26, v26, v52
  v_cvt_pk_bf16_f32 v54, v26, v55
  v_and_b32 v55, 0xffff0000, v54
  v_lshlrev_b32 v26, 16, v54
  v_mul_f32 v26, v26, v53
  v_cvt_pk_bf16_f32 v54, v26, v55
  v_and_b32 v55, 0xffff0000, v54
  v_lshlrev_b32 v26, 16, v54
  v_sub_f32 v28, v28, v52
  v_cvt_pk_bf16_f32 v54, v28, v55
  v_and_b32 v55, 0xffff0000, v54
  v_lshlrev_b32 v28, 16, v54
  v_mul_f32 v28, v28, v53
  v_cvt_pk_bf16_f32 v54, v28, v55
  v_and_b32 v55, 0xffff0000, v54
  v_lshlrev_b32 v28, 16, v54
  v_sub_f32 v30, v30, v52
  v_cvt_pk_bf16_f32 v54, v30, v55
  v_and_b32 v55, 0xffff0000, v54
  v_lshlrev_b32 v30, 16, v54
  v_mul_f32 v30, v30, v53
  v_cvt_pk_bf16_f32 v54, v30, v55
  v_and_b32 v55, 0xffff0000, v54
  v_lshlrev_b32 v30, 16, v54
  v_add_f32 v52, v34, v35
  v_add_f32 v52, v52, v38
  v_add_f32 v52, v52, v39
  v_add_f32 v52, v52, v42
  v_add_f32 v52, v52, v43
  v_add_f32 v52, v52, v46
  v_add_f32 v52, v52, v47
  v_add_f32 v52, v52, v50
  v_add_f32 v52, v52, v51
  s_nop 1
  v_add_f32_dpp v53, v52, v52 row_ror:8 row_mask:0xf bank_mask:0xf
  s_nop 1
  v_add_f32_dpp v53, v53, v53 row_ror:4 row_mask:0xf bank_mask:0xf
  s_nop 1
  v_add_f32_dpp v53, v53, v53 row_ror:2 row_mask:0xf bank_mask:0xf
  s_nop 1
  v_add_f32_dpp v53, v53, v53 row_ror:1 row_mask:0xf bank_mask:0xf
  s_nop 1
  v_add_f32_dpp v53, v53, v53 row_bcast:15 row_mask:0xa bank_mask:0xf
  s_nop 1
  v_add_f32_dpp v53, v53, v53 row_bcast:31 row_mask:0xc bank_mask:0xf
  s_nop 0
  v_readlane_b32 s57, v53, 63
  s_nop 1
  v_mov_b32 v52, s57
  v_mul_f32 v52, 0x3acccccd, v52
  v_sub_f32 v54, v34, v52
  v_mul_f32 v55, v54, v54
  v_sub_f32 v54, v35, v52
  v_fma_f32 v55, v54, v54, v55
  v_sub_f32 v54, v38, v52
  v_fma_f32 v55, v54, v54, v55
  v_sub_f32 v54, v39, v52
  v_fma_f32 v55, v54, v54, v55
  v_sub_f32 v54, v42, v52
  v_fma_f32 v55, v54, v54, v55
  v_sub_f32 v54, v43, v52
  v_fma_f32 v55, v54, v54, v55
  v_sub_f32 v54, v46, v52
  v_fma_f32 v55, v54, v54, v55
  v_sub_f32 v54, v47, v52
  v_fma_f32 v55, v54, v54, v55
  v_sub_f32 v54, v50, v52
  v_fma_f32 v55, v54, v54, v55
  v_sub_f32 v54, v51, v52
  v_fma_f32 v55, v54, v54, v55
  s_nop 1
  v_add_f32_dpp v53, v55, v55 row_ror:8 row_mask:0xf bank_mask:0xf
  s_nop 1
  v_add_f32_dpp v53, v53, v53 row_ror:4 row_mask:0xf bank_mask:0xf
  s_nop 1
  v_add_f32_dpp v53, v53, v53 row_ror:2 row_mask:0xf bank_mask:0xf
  s_nop 1
  v_add_f32_dpp v53, v53, v53 row_ror:1 row_mask:0xf bank_mask:0xf
  s_nop 1
  v_add_f32_dpp v53, v53, v53 row_bcast:15 row_mask:0xa bank_mask:0xf
  s_nop 1
  v_add_f32_dpp v53, v53, v53 row_bcast:31 row_mask:0xc bank_mask:0xf
  s_nop 0
  v_readlane_b32 s57, v53, 63
  s_nop 1
  v_mov_b32 v53, s57
  v_mul_f32 v53, 0x3acccccd, v53
  v_cvt_pk_bf16_f32 v54, v52, v53
  v_and_b32 v53, 0xffff0000, v54
  v_lshlrev_b32 v52, 16, v54
  v_add_f32 v53, 0x3727c5ac, v53
  v_mov_b32 v55, 0
  v_cvt_pk_bf16_f32 v54, v53, v55
  v_and_b32 v55, 0xffff0000, v54
  v_lshlrev_b32 v53, 16, v54
  v_sqrt_f32 v53, v53
  s_nop 0
  v_cvt_pk_bf16_f32 v54, v53, v55
  v_and_b32 v55, 0xffff0000, v54
  v_lshlrev_b32 v53, 16, v54
  v_rcp_f32 v53, v53
  s_nop 0
  v_sub_f32 v27, v27, v52
  v_cvt_pk_bf16_f32 v54, v27, v55
  v_and_b32 v55, 0xffff0000, v54
  v_lshlrev_b32 v27, 16, v54
  v_mul_f32 v27, v27, v53
  v_cvt_pk_bf16_f32 v54, v27, v55
  v_and_b32 v55, 0xffff0000, v54
  v_lshlrev_b32 v27, 16, v54
  v_sub_f32 v29, v29, v52
  v_cvt_pk_bf16_f32 v54, v29, v55
  v_and_b32 v55, 0xffff0000, v54
  v_lshlrev_b32 v29, 16, v54
  v_mul_f32 v29, v29, v53
  v_cvt_pk_bf16_f32 v54, v29, v55
  v_and_b32 v55, 0xffff0000, v54
  v_lshlrev_b32 v29, 16, v54
  v_sub_f32 v31, v31, v52
  v_cvt_pk_bf16_f32 v54, v31, v55
  v_and_b32 v55, 0xffff0000, v54
  v_lshlrev_b32 v31, 16, v54
  v_mul_f32 v31, v31, v53
  v_cvt_pk_bf16_f32 v54, v31, v55
  v_and_b32 v55, 0xffff0000, v54
  v_lshlrev_b32 v31, 16, v54
  v_lshlrev_b32 v9, 4, v0
  s_mul_i32 s57, s66, 2560
  s_add_u32 s57, s57, 2031616
  s_add_u32 s68, s57, 0
  s_add_u32 s69, s57, 20480
  s_add_u32 s70, s57, 40960
  s_add_u32 s71, s57, 61440
  s_add_u32 s72, s57, 10240
  s_add_u32 s73, s57, 30720
  s_add_u32 s74, s57, 51200
  s_add_u32 s75, s57, 71680
  v_mov_b32 v72, 0
  v_mov_b32 v73, s30
  v_mov_b32 v74, 0
  v_mov_b32 v75, s30
  v_mov_b32 v84, 0
  v_mov_b32 v85, s30
  v_mov_b32 v86, 0
  v_mov_b32 v87, s30
  v_mov_b32 v96, 0
  v_mov_b32 v97, s30
  v_mov_b32 v98, 0
  v_mov_b32 v99, s30
  v_mov_b32 v108, 0
  v_mov_b32 v109, s30
  v_mov_b32 v110, 0
  v_mov_b32 v111, s30
  v_mov_b32 v120, 0
  v_mov_b32 v121, s30
  v_mov_b32 v122, 0
  v_mov_b32 v123, s30
  v_mov_b32 v132, 0
  v_mov_b32 v133, s30
  v_mov_b32 v134, 0
  v_mov_b32 v135, s30
  v_mov_b32 v144, 0
  v_mov_b32 v145, s30
  v_mov_b32 v146, 0
  v_mov_b32 v147, s30
  v_mov_b32 v156, 0
  v_mov_b32 v157, s30
  v_mov_b32 v158, 0
  v_mov_b32 v159, s30
  s_waitcnt vmcnt(0)
  s_mov_b32 s56, 60000
L_poll_4:
  buffer_load_dwordx4 v[148:151], v9, s[36:39], s75 offen sc1
  s_waitcnt vmcnt(0)
  v_xor_b32 v10, s30, v149
  v_xor_b32 v11, s30, v151
  v_or_b32 v10, v10, v11
  v_cmp_ne_u32 vcc, 0, v10
  s_sub_u32 s56, s56, 1
  s_cmp_eq_u32 s56, 0
  s_cbranch_scc1 L_polld_5
  s_and_b64 vcc, exec, vcc
  s_cbranch_vccnz L_poll_4
L_polld_5:
  s_mov_b32 s56, 60000
L_poll_6:
  buffer_load_dwordx4 v[64:67], v9, s[36:39], s68 offen sc1
  buffer_load_dwordx4 v[68:71], v9, s[36:39], s68 offen offset:1024 sc1
  s_mov_b32 exec_lo, -1
  s_mov_b32 exec_hi, 0
  buffer_load_dwordx4 v[72:75], v9, s[36:39], s68 offen offset:2048 sc1
  s_mov_b64 exec, -1
  buffer_load_dwordx4 v[76:79], v9, s[36:39], s69 offen sc1
  buffer_load_dwordx4 v[80:83], v9, s[36:39], s69 offen offset:1024 sc1
  s_mov_b32 exec_lo, -1
  s_mov_b32 exec_hi, 0
  buffer_load_dwordx4 v[84:87], v9, s[36:39], s69 offen offset:2048 sc1
  s_mov_b64 exec, -1
  buffer_load_dwordx4 v[88:91], v9, s[36:39], s70 offen sc1
  buffer_load_dwordx4 v[92:95], v9, s[36:39], s70 offen offset:1024 sc1
  s_mov_b32 exec_lo, -1
  s_mov_b32 exec_hi, 0
  buffer_load_dwordx4 v[96:99], v9, s[36:39], s70 offen offset:2048 sc1
  s_mov_b64 exec, -1
  buffer_load_dwordx4 v[100:103], v9, s[36:39], s71 offen sc1
  buffer_load_dwordx4 v[104:107], v9, s[36:39], s71 offen offset:1024 sc1
  s_mov_b32 exec_lo, -1
  s_mov_b32 exec_hi, 0
  buffer_load_dwordx4 v[108:111], v9, s[36:39], s71 offen offset:2048 sc1
  s_mov_b64 exec, -1
  buffer_load_dwordx4 v[112:115], v9, s[36:39], s72 offen sc1
  buffer_load_dwordx4 v[116:119], v9, s[36:39], s72 offen offset:1024 sc1
  s_mov_b32 exec_lo, -1
  s_mov_b32 exec_hi, 0
  buffer_load_dwordx4 v[120:123], v9, s[36:39], s72 offen offset:2048 sc1
  s_mov_b64 exec, -1
  buffer_load_dwordx4 v[124:127], v9, s[36:39], s73 offen sc1
  buffer_load_dwordx4 v[128:131], v9, s[36:39], s73 offen offset:1024 sc1
  s_mov_b32 exec_lo, -1
  s_mov_b32 exec_hi, 0
  buffer_load_dwordx4 v[132:135], v9, s[36:39], s73 offen offset:2048 sc1
  s_mov_b64 exec, -1
  buffer_load_dwordx4 v[136:139], v9, s[36:39], s74 offen sc1
  buffer_load_dwordx4 v[140:143], v9, s[36:39], s74 offen offset:1024 sc1
  s_mov_b32 exec_lo, -1
  s_mov_b32 exec_hi, 0
  buffer_load_dwordx4 v[144:147], v9, s[36:39], s74 offen offset:2048 sc1
  s_mov_b64 exec, -1
  buffer_load_dwordx4 v[148:151], v9, s[36:39], s75 offen sc1
  buffer_load_dwordx4 v[152:155], v9, s[36:39], s75 offen offset:1024 sc1
  s_mov_b32 exec_lo, -1
  s_mov_b32 exec_hi, 0
  buffer_load_dwordx4 v[156:159], v9, s[36:39], s75 offen offset:2048 sc1
  s_mov_b64 exec, -1
  s_waitcnt vmcnt(0)
  v_max3_u32 v10, s30, v65, v67
  v_min3_u32 v11, s30, v65, v67
  v_max3_u32 v10, v10, v69, v71
  v_min3_u32 v11, v11, v69, v71
  v_max3_u32 v10, v10, v73, v75
  v_min3_u32 v11, v11, v73, v75
  v_max3_u32 v10, v10, v77, v79
  v_min3_u32 v11, v11, v77, v79
  v_max3_u32 v10, v10, v81, v83
  v_min3_u32 v11, v11, v81, v83
  v_max3_u32 v10, v10, v85, v87
  v_min3_u32 v11, v11, v85, v87
  v_max3_u32 v10, v10, v89, v91
  v_min3_u32 v11, v11, v89, v91
  v_max3_u32 v10, v10, v93, v95
  v_min3_u32 v11, v11, v93, v95
  v_max3_u32 v10, v10, v97, v99
  v_min3_u32 v11, v11, v97, v99
  v_max3_u32 v10, v10, v101, v103
  v_min3_u32 v11, v11, v101, v103
  v_max3_u32 v10, v10, v105, v107
  v_min3_u32 v11, v11, v105, v107
  v_max3_u32 v10, v10, v109, v111
  v_min3_u32 v11, v11, v109, v111
  v_max3_u32 v10, v10, v113, v115
  v_min3_u32 v11, v11, v113, v115
  v_max3_u32 v10, v10, v117, v119
  v_min3_u32 v11, v11, v117, v119
  v_max3_u32 v10, v10, v121, v123
  v_min3_u32 v11, v11, v121, v123
  v_max3_u32 v10, v10, v125, v127
  v_min3_u32 v11, v11, v125, v127
  v_max3_u32 v10, v10, v129, v131
  v_min3_u32 v11, v11, v129, v131
  v_max3_u32 v10, v10, v133, v135
  v_min3_u32 v11, v11, v133, v135
  v_max3_u32 v10, v10, v137, v139
  v_min3_u32 v11, v11, v137, v139
  v_max3_u32 v10, v10, v141, v143
  v_min3_u32 v11, v11, v141, v143
  v_max3_u32 v10, v10, v145, v147
  v_min3_u32 v11, v11, v145, v147
  v_max3_u32 v10, v10, v149, v151
  v_min3_u32 v11, v11, v149, v151
  v_max3_u32 v10, v10, v153, v155
  v_min3_u32 v11, v11, v153, v155
  v_max3_u32 v10, v10, v157, v159
  v_min3_u32 v11, v11, v157, v159
  v_xor_b32 v10, v10, v11
  v_cmp_ne_u32 vcc, 0, v10
  s_sub_u32 s56, s56, 1
  s_cmp_eq_u32 s56, 0
  s_cbranch_scc1 L_polld_7
  s_and_b64 vcc, exec, vcc
  s_cbranch_vccnz L_poll_6
L_polld_7:
  v_lshlrev_b32 v8, 1, v0
  v_add_u32 v8, 145920, v8
  v_add_f32 v64, v64, v76
  v_add_f32 v88, v88, v100
  v_add_f32 v66, v66, v78
  v_add_f32 v90, v90, v102
  v_add_f32 v64, v64, v88
  v_add_f32 v66, v66, v90
  v_cvt_pk_bf16_f32 v52, v64, v66
  v_and_b32 v66, 0xffff0000, v52
  v_lshlrev_b32 v64, 16, v52
  v_add_f32 v112, v112, v124
  v_add_f32 v136, v136, v148
  v_add_f32 v114, v114, v126
  v_add_f32 v138, v138, v150
  v_add_f32 v112, v112, v136
  v_add_f32 v114, v114, v138
  v_cvt_pk_bf16_f32 v52, v112, v114
  v_and_b32 v114, 0xffff0000, v52
  v_lshlrev_b32 v112, 16, v52
  v_add_f32 v112, 1.0, v112
  v_add_f32 v114, 1.0, v114
  v_cvt_pk_bf16_f32 v52, v112, v114
  v_and_b32 v114, 0xffff0000, v52
  v_lshlrev_b32 v112, 16, v52
  v_mul_f32 v26, v26, v112
  v_mul_f32 v27, v27, v114
  v_cvt_pk_bf16_f32 v52, v26, v27
  v_and_b32 v27, 0xffff0000, v52
  v_lshlrev_b32 v26, 16, v52
  v_add_f32 v26, v26, v64
  v_add_f32 v27, v27, v66
  v_cvt_pk_bf16_f32 v26, v26, v27
  ds_write_b16 v8, v26 offset:0
  ds_write_b16_d16_hi v8, v26 offset:320
  v_add_f32 v68, v68, v80
  v_add_f32 v92, v92, v104
  v_add_f32 v70, v70, v82
  v_add_f32 v94, v94, v106
  v_add_f32 v68, v68, v92
  v_add_f32 v70, v70, v94
  v_cvt_pk_bf16_f32 v52, v68, v70
  v_and_b32 v70, 0xffff0000, v52
  v_lshlrev_b32 v68, 16, v52
  v_add_f32 v116, v116, v128
  v_add_f32 v140, v140, v152
  v_add_f32 v118, v118, v130
  v_add_f32 v142, v142, v154
  v_add_f32 v116, v116, v140
  v_add_f32 v118, v118, v142
  v_cvt_pk_bf16_f32 v52, v116, v118
  v_and_b32 v118, 0xffff0000, v52
  v_lshlrev_b32 v116, 16, v52
  v_add_f32 v116, 1.0, v116
  v_add_f32 v118, 1.0, v118
  v_cvt_pk_bf16_f32 v52, v116, v118
  v_and_b32 v118, 0xffff0000, v52
  v_lshlrev_b32 v116, 16, v52
  v_mul_f32 v28, v28, v116
  v_mul_f32 v29, v29, v118
  v_cvt_pk_bf16_f32 v52, v28, v29
  v_and_b32 v29, 0xffff0000, v52
  v_lshlrev_b32 v28, 16, v52
  v_add_f32 v28, v28, v68
  v_add_f32 v29, v29, v70
  v_cvt_pk_bf16_f32 v28, v28, v29
  ds_write_b16 v8, v28 offset:128
  ds_write_b16_d16_hi v8, v28 offset:448
  v_add_f32 v72, v72, v84
  v_add_f32 v96, v96, v108
  v_add_f32 v74, v74, v86
  v_add_f32 v98, v98, v110
  v_add_f32 v72, v72, v96
  v_add_f32 v74, v74, v98
  v_cvt_pk_bf16_f32 v52, v72, v74
  v_and_b32 v74, 0xffff0000, v52
  v_lshlrev_b32 v72, 16, v52
  v_add_f32 v120, v120, v132
  v_add_f32 v144, v144, v156
  v_add_f32 v122, v122, v134
  v_add_f32 v146, v146, v158
  v_add_f32 v120, v120, v144
  v_add_f32 v122, v122, v146
  v_cvt_pk_bf16_f32 v52, v120, v122
  v_and_b32 v122, 0xffff0000, v52
  v_lshlrev_b32 v120, 16, v52
  v_add_f32 v120, 1.0, v120
  v_add_f32 v122, 1.0, v122
  v_cvt_pk_bf16_f32 v52, v120, v122
  v_and_b32 v122, 0xffff0000, v52
  v_lshlrev_b32 v120, 16, v52
  v_mul_f32 v30, v30, v120
  v_mul_f32 v31, v31, v122
  v_cvt_pk_bf16_f32 v52, v30, v31
  v_and_b32 v31, 0xffff0000, v52
  v_lshlrev_b32 v30, 16, v52
  v_add_f32 v30, v30, v72
  v_add_f32 v31, v31, v74
  v_cvt_pk_bf16_f32 v30, v30, v31
  s_mov_b32 exec_hi, 0
  ds_write_b16 v8, v30 offset:256
  ds_write_b16_d16_hi v8, v30 offset:576
  s_mov_b64 exec, -1
  s_sub_u32 s67, s31, 5
  s_lshr_b32 s66, s33, 1
  s_mul_i32 s57, s67, 20480
  s_add_u32 s57, s57, 0
  v_and_b32 v1, 1, v0
  v_mul_u32_u24 v6, 320, v1
  v_lshrrev_b32 v1, 4, v0
  v_lshl_add_u32 v6, v1, 4, v6
  v_add_u32 v6, 145920, v6
  v_lshlrev_b32 v7, 3, v1
  v_bfe_u32 v1, v0, 2, 2
  v_add_u32 v7, v7, v1
  v_mul_u32_u24 v7, 128, v7
  v_and_b32 v1, 3, v0
  v_lshl_add_u32 v7, v1, 3, v7
  v_add_u32 v7, s57, v7
  s_lshl_b32 s57, s32, 13
  s_lshl_b32 s58, s66, 11
  s_add_u32 s57, s57, s58
  s_lshl_b32 s58, s67, 10
  s_add_u32 s57, s57, s58
  s_add_u32 s59, s57, 2129920
  s_waitcnt vmcnt(0) lgkmcnt(0)
  s_barrier
  ds_read_b128 v[64:67], v6 offset:0
  ds_read_b64_tr_b16 v[68:69], v7 offset:0
  ds_read_b64_tr_b16 v[70:71], v7 offset:512
  ds_read_b64_tr_b16 v[72:73], v7 offset:32
  ds_read_b64_tr_b16 v[74:75], v7 offset:544
  ds_read_b64_tr_b16 v[76:77], v7 offset:64
  ds_read_b64_tr_b16 v[78:79], v7 offset:576
  ds_read_b64_tr_b16 v[80:81], v7 offset:96
  ds_read_b64_tr_b16 v[82:83], v7 offset:608
  ds_read_b128 v[84:87], v6 offset:64
  ds_read_b64_tr_b16 v[88:89], v7 offset:4096
  ds_read_b64_tr_b16 v[90:91], v7 offset:4608
  ds_read_b64_tr_b16 v[92:93], v7 offset:4128
  ds_read_b64_tr_b16 v[94:95], v7 offset:4640
  ds_read_b64_tr_b16 v[96:97], v7 offset:4160
  ds_read_b64_tr_b16 v[98:99], v7 offset:4672
  ds_read_b64_tr_b16 v[100:101], v7 offset:4192
  ds_read_b64_tr_b16 v[102:103], v7 offset:4704
  ds_read_b128 v[104:107], v6 offset:128
  ds_read_b64_tr_b16 v[108:109], v7 offset:8192
  ds_read_b64_tr_b16 v[110:111], v7 offset:8704
  ds_read_b64_tr_b16 v[112:113], v7 offset:8224
  ds_read_b64_tr_b16 v[114:115], v7 offset:8736
  ds_read_b64_tr_b16 v[116:117], v7 offset:8256
  ds_read_b64_tr_b16 v[118:119], v7 offset:8768
  ds_read_b64_tr_b16 v[120:121], v7 offset:8288
  ds_read_b64_tr_b16 v[122:123], v7 offset:8800
  ds_read_b128 v[124:127], v6 offset:192
  ds_read_b64_tr_b16 v[128:129], v7 offset:12288
  ds_read_b64_tr_b16 v[130:131], v7 offset:12800
  ds_read_b64_tr_b16 v[132:133], v7 offset:12320
  ds_read_b64_tr_b16 v[134:135], v7 offset:12832
  ds_read_b64_tr_b16 v[136:137], v7 offset:12352
  ds_read_b64_tr_b16 v[138:139], v7 offset:12864
  ds_read_b64_tr_b16 v[140:141], v7 offset:12384
  ds_read_b64_tr_b16 v[142:143], v7 offset:12896
  ds_read_b128 v[144:147], v6 offset:256
  ds_read_b64_tr_b16 v[148:149], v7 offset:16384
  ds_read_b64_tr_b16 v[150:151], v7 offset:16896
  ds_read_b64_tr_b16 v[152:153], v7 offset:16416
  ds_read_b64_tr_b16 v[154:155], v7 offset:16928
  ds_read_b64_tr_b16 v[156:157], v7 offset:16448
  ds_read_b64_tr_b16 v[158:159], v7 offset:16960
  ds_read_b64_tr_b16 v[160:161], v7 offset:16480
  ds_read_b64_tr_b16 v[162:163], v7 offset:16992
  s_waitcnt lgkmcnt(15)
  v_mfma_f32_16x16x32_bf16 v[24:27], v[64:67], v[68:71], 0
  v_mfma_f32_16x16x32_bf16 v[28:31], v[64:67], v[72:75], 0
  v_mfma_f32_16x16x32_bf16 v[32:35], v[64:67], v[76:79], 0
  v_mfma_f32_16x16x32_bf16 v[36:39], v[64:67], v[80:83], 0
  s_waitcnt lgkmcnt(15)
  v_mfma_f32_16x16x32_bf16 v[24:27], v[84:87], v[88:91], v[24:27]
  v_mfma_f32_16x16x32_bf16 v[28:31], v[84:87], v[92:95], v[28:31]
  v_mfma_f32_16x16x32_bf16 v[32:35], v[84:87], v[96:99], v[32:35]
  v_mfma_f32_16x16x32_bf16 v[36:39], v[84:87], v[100:103], v[36:39]
  s_waitcnt lgkmcnt(15)
  v_mfma_f32_16x16x32_bf16 v[24:27], v[104:107], v[108:111], v[24:27]
  v_mfma_f32_16x16x32_bf16 v[28:31], v[104:107], v[112:115], v[28:31]
  v_mfma_f32_16x16x32_bf16 v[32:35], v[104:107], v[116:119], v[32:35]
  v_mfma_f32_16x16x32_bf16 v[36:39], v[104:107], v[120:123], v[36:39]
  s_waitcnt lgkmcnt(9)
  v_mfma_f32_16x16x32_bf16 v[24:27], v[124:127], v[128:131], v[24:27]
  v_mfma_f32_16x16x32_bf16 v[28:31], v[124:127], v[132:135], v[28:31]
  v_mfma_f32_16x16x32_bf16 v[32:35], v[124:127], v[136:139], v[32:35]
  v_mfma_f32_16x16x32_bf16 v[36:39], v[124:127], v[140:143], v[36:39]
  s_waitcnt lgkmcnt(0)
  v_mfma_f32_16x16x32_bf16 v[24:27], v[144:147], v[148:151], v[24:27]
  v_mfma_f32_16x16x32_bf16 v[28:31], v[144:147], v[152:155], v[28:31]
  v_mfma_f32_16x16x32_bf16 v[32:35], v[144:147], v[156:159], v[32:35]
  v_mfma_f32_16x16x32_bf16 v[36:39], v[144:147], v[160:163], v[36:39]
  s_nop 7
  v_lshlrev_b32 v1, 4, v0
  v_mov_b32 v200, v24
  v_mov_b32 v201, s30
  v_mov_b32 v202, v25
  v_mov_b32 v203, s30
  v_mov_b32 v204, v28
  v_mov_b32 v205, s30
  v_mov_b32 v206, v29
  v_mov_b32 v207, s30
  v_mov_b32 v208, v32
  v_mov_b32 v209, s30
  v_mov_b32 v210, v33
  v_mov_b32 v211, s30
  v_mov_b32 v212, v36
  v_mov_b32 v213, s30
  v_mov_b32 v214, v37
  v_mov_b32 v215, s30
  s_mov_b64 exec, 0xffff
  buffer_store_dwordx4 v[200:203], v1, s[36:39], s59 offen offset:0 sc1
  buffer_store_dwordx4 v[204:207], v1, s[36:39], s59 offen offset:256 sc1
  buffer_store_dwordx4 v[208:211], v1, s[36:39], s59 offen offset:512 sc1
  buffer_store_dwordx4 v[212:215], v1, s[36:39], s59 offen offset:768 sc1
  s_mov_b64 exec, -1
  s_barrier
  v_lshlrev_b32 v9, 4, v0
  s_lshl_b32 s57, s32, 13
  s_add_u32 s57, s57, 2129920
  s_add_u32 s58, s57, 4096
  s_mov_b32 s56, 60000
L_poll_8:
  buffer_load_dwordx4 v[64:67], v9, s[36:39], s57 offen sc1
  buffer_load_dwordx4 v[68:71], v9, s[36:39], s57 offen offset:1024 sc1
  buffer_load_dwordx4 v[72:75], v9, s[36:39], s57 offen offset:2048 sc1
  buffer_load_dwordx4 v[76:79], v9, s[36:39], s57 offen offset:3072 sc1
  buffer_load_dwordx4 v[80:83], v9, s[36:39], s58 offen sc1
  buffer_load_dwordx4 v[84:87], v9, s[36:39], s58 offen offset:1024 sc1
  buffer_load_dwordx4 v[88:91], v9, s[36:39], s58 offen offset:2048 sc1
  buffer_load_dwordx4 v[92:95], v9, s[36:39], s58 offen offset:3072 sc1
  s_waitcnt vmcnt(0)
  v_max3_u32 v10, s30, v65, v67
  v_min3_u32 v11, s30, v65, v67
  v_max3_u32 v10, v10, v69, v71
  v_min3_u32 v11, v11, v69, v71
  v_max3_u32 v10, v10, v73, v75
  v_min3_u32 v11, v11, v73, v75
  v_max3_u32 v10, v10, v77, v79
  v_min3_u32 v11, v11, v77, v79
  v_max3_u32 v10, v10, v81, v83
  v_min3_u32 v11, v11, v81, v83
  v_max3_u32 v10, v10, v85, v87
  v_min3_u32 v11, v11, v85, v87
  v_max3_u32 v10, v10, v89, v91
  v_min3_u32 v11, v11, v89, v91
  v_max3_u32 v10, v10, v93, v95
  v_min3_u32 v11, v11, v93, v95
  v_xor_b32 v10, v10, v11
  v_cmp_ne_u32 vcc, 0, v10
  s_sub_u32 s56, s56, 1
  s_cmp_eq_u32 s56, 0
  s_cbranch_scc1 L_polld_9
  s_and_b64 vcc, exec, vcc
  s_cbranch_vccnz L_poll_8
L_polld_9:
  v_lshlrev_b32 v3, 1, v0
  v_add_u32 v3, 148480, v3
  v_add_f32 v64, v64, v72
  v_add_f32 v80, v80, v88
  v_add_f32 v66, v66, v74
  v_add_f32 v82, v82, v90
  v_add_f32 v64, v64, v80
  v_add_f32 v66, v66, v82
  v_cvt_pk_bf16_f32 v64, v64, v66
  ds_write_b16 v3, v64 offset:0
  ds_write_b16_d16_hi v3, v64 offset:256
  v_add_f32 v68, v68, v76
  v_add_f32 v84, v84, v92
  v_add_f32 v70, v70, v78
  v_add_f32 v86, v86, v94
  v_add_f32 v68, v68, v84
  v_add_f32 v70, v70, v86
  v_cvt_pk_bf16_f32 v68, v68, v70
  ds_write_b16 v3, v68 offset:128
  ds_write_b16_d16_hi v3, v68 offset:384
  s_waitcnt lgkmcnt(0)
  s_branch L_hb1
L_hq6:
  s_mov_b32 s40, s10
  s_and_b32 s41, s11, 0xffff
  s_mov_b32 s42, 0x500000
  s_mov_b32 s43, 0x20000
  s_sub_u32 s67, s31, 5
  s_lshr_b32 s66, s33, 1
  s_mul_i32 s52, s66, 1310720
  s_lshl_b32 s57, s32, 8
  s_add_u32 s52, s52, s57
  s_lshl_b32 s57, s67, 7
  s_add_u32 s52, s52, s57
  v_lshrrev_b32 v1, 3, v0
  v_mul_u32_u24 v2, 8192, v1
  v_and_b32 v1, 7, v0
  v_lshl_add_u32 v2, v1, 4, v2
  s_mul_i32 s53, s67, 20480
  s_add_u32 s53, s53, 0
  s_mov_b32 m0, s53
  s_add_u32 s53, s53, 1024
  buffer_load_dwordx4 v2, s[40:43], s52 offen nt lds
  s_add_u32 s52, s52, 65536
  s_mov_b32 m0, s53
  s_add_u32 s53, s53, 1024
  buffer_load_dwordx4 v2, s[40:43], s52 offen nt lds
  s_add_u32 s52, s52, 65536
  s_mov_b32 m0, s53
  s_add_u32 s53, s53, 1024
  buffer_load_dwordx4 v2, s[40:43], s52 offen nt lds
  s_add_u32 s52, s52, 65536
  s_mov_b32 m0, s53
  s_add_u32 s53, s53, 1024
  buffer_load_dwordx4 v2, s[40:43], s52 offen nt lds
  s_add_u32 s52, s52, 65536
  s_mov_b32 m0, s53
  s_add_u32 s53, s53, 1024
  buffer_load_dwordx4 v2, s[40:43], s52 offen nt lds
  s_add_u32 s52, s52, 65536
  s_mov_b32 m0, s53
  s_add_u32 s53, s53, 1024
  buffer_load_dwordx4 v2, s[40:43], s52 offen nt lds
  s_add_u32 s52, s52, 65536
  s_mov_b32 m0, s53
  s_add_u32 s53, s53, 1024
  buffer_load_dwordx4 v2, s[40:43], s52 offen nt lds
  s_add_u32 s52, s52, 65536
  s_mov_b32 m0, s53
  s_add_u32 s53, s53, 1024
  buffer_load_dwordx4 v2, s[40:43], s52 offen nt lds
  s_add_u32 s52, s52, 65536
  s_mov_b32 m0, s53
  s_add_u32 s53, s53, 1024
  buffer_load_dwordx4 v2, s[40:43], s52 offen nt lds
  s_add_u32 s52, s52, 65536
  s_mov_b32 m0, s53
  s_add_u32 s53, s53, 1024
  buffer_load_dwordx4 v2, s[40:43], s52 offen nt lds
  s_add_u32 s52, s52, 65536
  s_mov_b32 m0, s53
  s_add_u32 s53, s53, 1024
  buffer_load_dwordx4 v2, s[40:43], s52 offen nt lds
  s_add_u32 s52, s52, 65536
  s_mov_b32 m0, s53
  s_add_u32 s53, s53, 1024
  buffer_load_dwordx4 v2, s[40:43], s52 offen nt lds
  s_add_u32 s52, s52, 65536
  s_mov_b32 m0, s53
  s_add_u32 s53, s53, 1024
  buffer_load_dwordx4 v2, s[40:43], s52 offen nt lds
  s_add_u32 s52, s52, 65536
  s_mov_b32 m0, s53
  s_add_u32 s53, s53, 1024
  buffer_load_dwordx4 v2, s[40:43], s52 offen nt lds
  s_add_u32 s52, s52, 65536
  s_mov_b32 m0, s53
  s_add_u32 s53, s53, 1024
  buffer_load_dwordx4 v2, s[40:43], s52 offen nt lds
  s_add_u32 s52, s52, 65536
  s_mov_b32 m0, s53
  s_add_u32 s53, s53, 1024
  buffer_load_dwordx4 v2, s[40:43], s52 offen nt lds
  s_add_u32 s52, s52, 65536
  s_mov_b32 m0, s53
  s_add_u32 s53, s53, 1024
  buffer_load_dwordx4 v2, s[40:43], s52 offen nt lds
  s_add_u32 s52, s52, 65536
  s_mov_b32 m0, s53
  s_add_u32 s53, s53, 1024
  buffer_load_dwordx4 v2, s[40:43], s52 offen nt lds
  s_add_u32 s52, s52, 65536
  s_mov_b32 m0, s53
  s_add_u32 s53, s53, 1024
  buffer_load_dwordx4 v2, s[40:43], s52 offen nt lds
  s_add_u32 s52, s52, 65536
  s_mov_b32 m0, s53
  s_add_u32 s53, s53, 1024
  buffer_load_dwordx4 v2, s[40:43], s52 offen nt lds
  s_add_u32 s52, s52, 65536
  s_waitcnt lgkmcnt(0)
  s_add_u32 s30, s30, 0x9e3779b9
  s_sub_u32 s67, s31, 5
  s_lshr_b32 s66, s33, 1
  s_mul_i32 s57, s67, 20480
  s_add_u32 s57, s57, 0
  v_and_b32 v1, 1, v0
  v_mul_u32_u24 v6, 320, v1
  v_lshrrev_b32 v1, 4, v0
  v_lshl_add_u32 v6, v1, 4, v6
  v_add_u32 v6, 145920, v6
  v_lshlrev_b32 v7, 3, v1
  v_bfe_u32 v1, v0, 2, 2
  v_add_u32 v7, v7, v1
  v_mul_u32_u24 v7, 128, v7
  v_and_b32 v1, 3, v0
  v_lshl_add_u32 v7, v1, 3, v7
  v_add_u32 v7, s57, v7
  s_lshl_b32 s57, s32, 13
  s_lshl_b32 s58, s66, 11
  s_add_u32 s57, s57, s58
  s_lshl_b32 s58, s67, 10
  s_add_u32 s57, s57, s58
  s_add_u32 s59, s57, 2129920
  s_waitcnt vmcnt(0) lgkmcnt(0)
  s_barrier
  ds_read_b128 v[64:67], v6 offset:0
  ds_read_b64_tr_b16 v[68:69], v7 offset:0
  ds_read_b64_tr_b16 v[70:71], v7 offset:512
  ds_read_b64_tr_b16 v[72:73], v7 offset:32
  ds_read_b64_tr_b16 v[74:75], v7 offset:544
  ds_read_b64_tr_b16 v[76:77], v7 offset:64
  ds_read_b64_tr_b16 v[78:79], v7 offset:576
  ds_read_b64_tr_b16 v[80:81], v7 offset:96
  ds_read_b64_tr_b16 v[82:83], v7 offset:608
  ds_read_b128 v[84:87], v6 offset:64
  ds_read_b64_tr_b16 v[88:89], v7 offset:4096
  ds_read_b64_tr_b16 v[90:91], v7 offset:4608
  ds_read_b64_tr_b16 v[92:93], v7 offset:4128
  ds_read_b64_tr_b16 v[94:95], v7 offset:4640
  ds_read_b64_tr_b16 v[96:97], v7 offset:4160
  ds_read_b64_tr_b16 v[98:99], v7 offset:4672
  ds_read_b64_tr_b16 v[100:101], v7 offset:4192
  ds_read_b64_tr_b16 v[102:103], v7 offset:4704
  ds_read_b128 v[104:107], v6 offset:128
  ds_read_b64_tr_b16 v[108:109], v7 offset:8192
  ds_read_b64_tr_b16 v[110:111], v7 offset:8704
  ds_read_b64_tr_b16 v[112:113], v7 offset:8224
  ds_read_b64_tr_b16 v[114:115], v7 offset:8736
  ds_read_b64_tr_b16 v[116:117], v7 offset:8256
  ds_read_b64_tr_b16 v[118:119], v7 offset:8768
  ds_read_b64_tr_b16 v[120:121], v7 offset:8288
  ds_read_b64_tr_b16 v[122:123], v7 offset:8800
  ds_read_b128 v[124:127], v6 offset:192
  ds_read_b64_tr_b16 v[128:129], v7 offset:12288
  ds_read_b64_tr_b16 v[130:131], v7 offset:12800
  ds_read_b64_tr_b16 v[132:133], v7 offset:12320
  ds_read_b64_tr_b16 v[134:135], v7 offset:12832
  ds_read_b64_tr_b16 v[136:137], v7 offset:12352
  ds_read_b64_tr_b16 v[138:139], v7 offset:12864
  ds_read_b64_tr_b16 v[140:141], v7 offset:12384
  ds_read_b64_tr_b16 v[142:143], v7 offset:12896
  ds_read_b128 v[144:147], v6 offset:256
  ds_read_b64_tr_b16 v[148:149], v7 offset:16384
  ds_read_b64_tr_b16 v[150:151], v7 offset:16896
  ds_read_b64_tr_b16 v[152:153], v7 offset:16416
  ds_read_b64_tr_b16 v[154:155], v7 offset:16928
  ds_read_b64_tr_b16 v[156:157], v7 offset:16448
  ds_read_b64_tr_b16 v[158:159], v7 offset:16960
  ds_read_b64_tr_b16 v[160:161], v7 offset:16480
  ds_read_b64_tr_b16 v[162:163], v7 offset:16992
  s_waitcnt lgkmcnt(15)
  v_mfma_f32_16x16x32_bf16 v[24:27], v[64:67], v[68:71], 0
  v_mfma_f32_16x16x32_bf16 v[28:31], v[64:67], v[72:75], 0
  v_mfma_f32_16x16x32_bf16 v[32:35], v[64:67], v[76:79], 0
  v_mfma_f32_16x16x32_bf16 v[36:39], v[64:67], v[80:83], 0
  s_waitcnt lgkmcnt(15)
  v_mfma_f32_16x16x32_bf16 v[24:27], v[84:87], v[88:91], v[24:27]
  v_mfma_f32_16x16x32_bf16 v[28:31], v[84:87], v[92:95], v[28:31]
  v_mfma_f32_16x16x32_bf16 v[32:35], v[84:87], v[96:99], v[32:35]
  v_mfma_f32_16x16x32_bf16 v[36:39], v[84:87], v[100:103], v[36:39]
  s_waitcnt lgkmcnt(15)
  v_mfma_f32_16x16x32_bf16 v[24:27], v[104:107], v[108:111], v[24:27]
  v_mfma_f32_16x16x32_bf16 v[28:31], v[104:107], v[112:115], v[28:31]
  v_mfma_f32_16x16x32_bf16 v[32:35], v[104:107], v[116:119], v[32:35]
  v_mfma_f32_16x16x32_bf16 v[36:39], v[104:107], v[120:123], v[36:39]
  s_waitcnt lgkmcnt(9)
  v_mfma_f32_16x16x32_bf16 v[24:27], v[124:127], v[128:131], v[24:27]
  v_mfma_f32_16x16x32_bf16 v[28:31], v[124:127], v[132:135], v[28:31]
  v_mfma_f32_16x16x32_bf16 v[32:35], v[124:127], v[136:139], v[32:35]
  v_mfma_f32_16x16x32_bf16 v[36:39], v[124:127], v[140:143], v[36:39]
  s_waitcnt lgkmcnt(0)
  v_mfma_f32_16x16x32_bf16 v[24:27], v[144:147], v[148:151], v[24:27]
  v_mfma_f32_16x16x32_bf16 v[28:31], v[144:147], v[152:155], v[28:31]
  v_mfma_f32_16x16x32_bf16 v[32:35], v[144:147], v[156:159], v[32:35]
  v_mfma_f32_16x16x32_bf16 v[36:39], v[144:147], v[160:163], v[36:39]
  s_nop 7
  v_lshlrev_b32 v1, 4, v0
  v_mov_b32 v200, v24
  v_mov_b32 v201, s30
  v_mov_b32 v202, v25
  v_mov_b32 v203, s30
  v_mov_b32 v204, v28
  v_mov_b32 v205, s30
  v_mov_b32 v206, v29
  v_mov_b32 v207, s30
  v_mov_b32 v208, v32
  v_mov_b32 v209, s30
  v_mov_b32 v210, v33
  v_mov_b32 v211, s30
  v_mov_b32 v212, v36
  v_mov_b32 v213, s30
  v_mov_b32 v214, v37
  v_mov_b32 v215, s30
  s_mov_b64 exec, 0xffff
  buffer_store_dwordx4 v[200:203], v1, s[36:39], s59 offen offset:0 sc1
  buffer_store_dwordx4 v[204:207], v1, s[36:39], s59 offen offset:256 sc1
  buffer_store_dwordx4 v[208:211], v1, s[36:39], s59 offen offset:512 sc1
  buffer_store_dwordx4 v[212:215], v1, s[36:39], s59 offen offset:768 sc1
  s_mov_b64 exec, -1
  s_barrier
  s_branch L_hb1
L_hb0:
  s_waitcnt lgkmcnt(0)
  s_add_u32 s30, s30, 0x9e3779b9
L_hba:
  s_barrier
  s_barrier
L_hb1:
  s_barrier
  s_cmp_eq_u32 s95, 1
  s_cbranch_scc1 L_nob1b
  s_barrier
L_nob1b:
  s_cmp_eq_u32 s31, 4
  s_cbranch_scc1 L_h4
  s_cmp_eq_u32 s34, 1
  s_cbranch_scc1 L_hffn
  s_cmp_eq_u32 s34, 0
  s_cbranch_scc0 L_hb2
  s_cmp_eq_u32 s31, 7
  s_cbranch_scc1 L_hwo
  s_cmp_eq_u32 s31, 6
  s_cbranch_scc0 L_hb2
  s_lshl_b32 s65, s33, 5
  s_add_u32 s65, s65, s32
  s_add_u32 s65, s65, 80
  s_mov_b32 s40, s24
  s_and_b32 s41, s25, 0xffff
  s_mov_b32 s42, 0x4b0000
  s_mov_b32 s43, 0x20000
  s_mov_b32 s48, s22
  s_and_b32 s49, s23, 0xffff
  s_mov_b32 s50, 0xa00
  s_mov_b32 s51, 0x20000
  v_lshlrev_b32 v3, 2, v0
  buffer_load_dword v16, v3, s[48:51], 0 offen offset:0
  buffer_load_dword v17, v3, s[48:51], 0 offen offset:256
  buffer_load_dword v18, v3, s[48:51], 0 offen offset:512
  buffer_load_dword v19, v3, s[48:51], 0 offen offset:768
  buffer_load_dword v20, v3, s[48:51], 0 offen offset:1024
  buffer_load_dword v21, v3, s[48:51], 0 offen offset:1280
  buffer_load_dword v22, v3, s[48:51], 0 offen offset:1536
  buffer_load_dword v23, v3, s[48:51], 0 offen offset:1792
  buffer_load_dword v24, v3, s[48:51], 0 offen offset:2048
  buffer_load_dword v25, v3, s[48:51], 0 offen offset:2304
  v_lshrrev_b32 v1, 1, v0
  v_mul_u32_u24 v2, 7680, v1
  v_and_b32 v1, 1, v0
  v_lshl_add_u32 v2, v1, 4, v2
  s_lshl_b32 s52, s65, 5
  s_mov_b32 m0, 40960
  s_nop 0
  buffer_load_dwordx4 v2, s[40:43], s52 offen nt lds
  s_mov_b32 m0, 41984
  s_add_u32 s52, s52, 245760
  buffer_load_dwordx4 v2, s[40:43], s52 offen nt lds
  s_mov_b32 m0, 43008
  s_add_u32 s52, s52, 245760
  buffer_load_dwordx4 v2, s[40:43], s52 offen nt lds
  s_mov_b32 m0, 44032
  s_add_u32 s52, s52, 245760
  buffer_load_dwordx4 v2, s[40:43], s52 offen nt lds
  s_mov_b32 m0, 45056
  s_add_u32 s52, s52, 245760
  buffer_load_dwordx4 v2, s[40:43], s52 offen nt lds
  s_mov_b32 m0, 46080
  s_add_u32 s52, s52, 245760
  buffer_load_dwordx4 v2, s[40:43], s52 offen nt lds
  s_mov_b32 m0, 47104
  s_add_u32 s52, s52, 245760
  buffer_load_dwordx4 v2, s[40:43], s52 offen nt lds
  s_mov_b32 m0, 48128
  s_add_u32 s52, s52, 245760
  buffer_load_dwordx4 v2, s[40:43], s52 offen nt lds
  s_mov_b32 m0, 49152
  s_add_u32 s52, s52, 245760
  buffer_load_dwordx4 v2, s[40:43], s52 offen nt lds
  s_mov_b32 m0, 50176
  s_add_u32 s52, s52, 245760
  buffer_load_dwordx4 v2, s[40:43], s52 offen nt lds
  s_mov_b32 m0, 51200
  s_add_u32 s52, s52, 245760
  buffer_load_dwordx4 v2, s[40:43], s52 offen nt lds
  s_mov_b32 m0, 52224
  s_add_u32 s52, s52, 245760
  buffer_load_dwordx4 v2, s[40:43], s52 offen nt lds
  s_mov_b32 m0, 53248
  s_add_u32 s52, s52, 245760
  buffer_load_dwordx4 v2, s[40:43], s52 offen nt lds
  s_mov_b32 m0, 54272
  s_add_u32 s52, s52, 245760
  buffer_load_dwordx4 v2, s[40:43], s52 offen nt lds
  s_mov_b32 m0, 55296
  s_add_u32 s52, s52, 245760
  buffer_load_dwordx4 v2, s[40:43], s52 offen nt lds
  s_mov_b32 m0, 56320
  s_add_u32 s52, s52, 245760
  buffer_load_dwordx4 v2, s[40:43], s52 offen nt lds
  s_mov_b32 m0, 57344
  s_add_u32 s52, s52, 245760
  buffer_load_dwordx4 v2, s[40:43], s52 offen nt lds
  s_mov_b32 m0, 58368
  s_add_u32 s52, s52, 245760
  buffer_load_dwordx4 v2, s[40:43], s52 offen nt lds
  s_mov_b32 m0, 59392
  s_add_u32 s52, s52, 245760
  buffer_load_dwordx4 v2, s[40:43], s52 offen nt lds
  s_mov_b32 m0, 60416
  s_add_u32 s52, s52, 245760
  buffer_load_dwordx4 v2, s[40:43], s52 offen nt lds
  s_waitcnt vmcnt(20)
  v_add_u32 v3, 143360, v3
  v_and_b32 v9, 0xffff0000, v16
  v_lshlrev_b32 v8, 16, v16
  v_mul_f32 v10, 0xbfb8aa3b, v8
  v_exp_f32 v10, v10
  s_nop 0
  v_add_f32 v10, 1.0, v10
  v_rcp_f32 v10, v10
  s_nop 0
  v_mul_f32 v8, v8, v10
  v_mul_f32 v11, 0xbfb8aa3b, v9
  v_exp_f32 v11, v11
  s_nop 0
  v_add_f32 v11, 1.0, v11
  v_rcp_f32 v11, v11
  s_nop 0
  v_mul_f32 v9, v9, v11
  v_cvt_pk_bf16_f32 v8, v8, v9
  ds_write_b32 v3, v8 offset:0
  v_and_b32 v9, 0xffff0000, v17
  v_lshlrev_b32 v8, 16, v17
  v_mul_f32 v10, 0xbfb8aa3b, v8
  v_exp_f32 v10, v10
  s_nop 0
  v_add_f32 v10, 1.0, v10
  v_rcp_f32 v10, v10
  s_nop 0
  v_mul_f32 v8, v8, v10
  v_mul_f32 v11, 0xbfb8aa3b, v9
  v_exp_f32 v11, v11
  s_nop 0
  v_add_f32 v11, 1.0, v11
  v_rcp_f32 v11, v11
  s_nop 0
  v_mul_f32 v9, v9, v11
  v_cvt_pk_bf16_f32 v8, v8, v9
  ds_write_b32 v3, v8 offset:256
  v_and_b32 v9, 0xffff0000, v18
  v_lshlrev_b32 v8, 16, v18
  v_mul_f32 v10, 0xbfb8aa3b, v8
  v_exp_f32 v10, v10
  s_nop 0
  v_add_f32 v10, 1.0, v10
  v_rcp_f32 v10, v10
  s_nop 0
  v_mul_f32 v8, v8, v10
  v_mul_f32 v11, 0xbfb8aa3b, v9
  v_exp_f32 v11, v11
  s_nop 0
  v_add_f32 v11, 1.0, v11
  v_rcp_f32 v11, v11
  s_nop 0
  v_mul_f32 v9, v9, v11
  v_cvt_pk_bf16_f32 v8, v8, v9
  ds_write_b32 v3, v8 offset:512
  v_and_b32 v9, 0xffff0000, v19
  v_lshlrev_b32 v8, 16, v19
  v_mul_f32 v10, 0xbfb8aa3b, v8
  v_exp_f32 v10, v10
  s_nop 0
  v_add_f32 v10, 1.0, v10
  v_rcp_f32 v10, v10
  s_nop 0
  v_mul_f32 v8, v8, v10
  v_mul_f32 v11, 0xbfb8aa3b, v9
  v_exp_f32 v11, v11
  s_nop 0
  v_add_f32 v11, 1.0, v11
  v_rcp_f32 v11, v11
  s_nop 0
  v_mul_f32 v9, v9, v11
  v_cvt_pk_bf16_f32 v8, v8, v9
  ds_write_b32 v3, v8 offset:768
  v_and_b32 v9, 0xffff0000, v20
  v_lshlrev_b32 v8, 16, v20
  v_mul_f32 v10, 0xbfb8aa3b, v8
  v_exp_f32 v10, v10
  s_nop 0
  v_add_f32 v10, 1.0, v10
  v_rcp_f32 v10, v10
  s_nop 0
  v_mul_f32 v8, v8, v10
  v_mul_f32 v11, 0xbfb8aa3b, v9
  v_exp_f32 v11, v11
  s_nop 0
  v_add_f32 v11, 1.0, v11
  v_rcp_f32 v11, v11
  s_nop 0
  v_mul_f32 v9, v9, v11
  v_cvt_pk_bf16_f32 v8, v8, v9
  ds_write_b32 v3, v8 offset:1024
  v_and_b32 v9, 0xffff0000, v21
  v_lshlrev_b32 v8, 16, v21
  v_mul_f32 v10, 0xbfb8aa3b, v8
  v_exp_f32 v10, v10
  s_nop 0
  v_add_f32 v10, 1.0, v10
  v_rcp_f32 v10, v10
  s_nop 0
  v_mul_f32 v8, v8, v10
  v_mul_f32 v11, 0xbfb8aa3b, v9
  v_exp_f32 v11, v11
  s_nop 0
  v_add_f32 v11, 1.0, v11
  v_rcp_f32 v11, v11
  s_nop 0
  v_mul_f32 v9, v9, v11
  v_cvt_pk_bf16_f32 v8, v8, v9
  ds_write_b32 v3, v8 offset:1280
  v_and_b32 v9, 0xffff0000, v22
  v_lshlrev_b32 v8, 16, v22
  v_mul_f32 v10, 0xbfb8aa3b, v8
  v_exp_f32 v10, v10
  s_nop 0
  v_add_f32 v10, 1.0, v10
  v_rcp_f32 v10, v10
  s_nop 0
  v_mul_f32 v8, v8, v10
  v_mul_f32 v11, 0xbfb8aa3b, v9
  v_exp_f32 v11, v11
  s_nop 0
  v_add_f32 v11, 1.0, v11
  v_rcp_f32 v11, v11
  s_nop 0
  v_mul_f32 v9, v9, v11
  v_cvt_pk_bf16_f32 v8, v8, v9
  ds_write_b32 v3, v8 offset:1536
  v_and_b32 v9, 0xffff0000, v23
  v_lshlrev_b32 v8, 16, v23
  v_mul_f32 v10, 0xbfb8aa3b, v8
  v_exp_f32 v10, v10
  s_nop 0
  v_add_f32 v10, 1.0, v10
  v_rcp_f32 v10, v10
  s_nop 0
  v_mul_f32 v8, v8, v10
  v_mul_f32 v11, 0xbfb8aa3b, v9
  v_exp_f32 v11, v11
  s_nop 0
  v_add_f32 v11, 1.0, v11
  v_rcp_f32 v11, v11
  s_nop 0
  v_mul_f32 v9, v9, v11
  v_cvt_pk_bf16_f32 v8, v8, v9
  ds_write_b32 v3, v8 offset:1792
  v_and_b32 v9, 0xffff0000, v24
  v_lshlrev_b32 v8, 16, v24
  v_mul_f32 v10, 0xbfb8aa3b, v8
  v_exp_f32 v10, v10
  s_nop 0
  v_add_f32 v10, 1.0, v10
  v_rcp_f32 v10, v10
  s_nop 0
  v_mul_f32 v8, v8, v10
  v_mul_f32 v11, 0xbfb8aa3b, v9
  v_exp_f32 v11, v11
  s_nop 0
  v_add_f32 v11, 1.0, v11
  v_rcp_f32 v11, v11
  s_nop 0
  v_mul_f32 v9, v9, v11
  v_cvt_pk_bf16_f32 v8, v8, v9
  ds_write_b32 v3, v8 offset:2048
  v_and_b32 v9, 0xffff0000, v25
  v_lshlrev_b32 v8, 16, v25
  v_mul_f32 v10, 0xbfb8aa3b, v8
  v_exp_f32 v10, v10
  s_nop 0
  v_add_f32 v10, 1.0, v10
  v_rcp_f32 v10, v10
  s_nop 0
  v_mul_f32 v8, v8, v10
  v_mul_f32 v11, 0xbfb8aa3b, v9
  v_exp_f32 v11, v11
  s_nop 0
  v_add_f32 v11, 1.0, v11
  v_rcp_f32 v11, v11
  s_nop 0
  v_mul_f32 v9, v9, v11
  v_cvt_pk_bf16_f32 v8, v8, v9
  ds_write_b32 v3, v8 offset:2304
  v_and_b32 v1, 1, v0
  v_mul_u32_u24 v6, 1280, v1
  v_lshrrev_b32 v1, 4, v0
  v_lshl_add_u32 v6, v1, 4, v6
  v_add_u32 v6, 143360, v6
  v_lshlrev_b32 v7, 3, v1
  v_bfe_u32 v1, v0, 2, 2
  v_add_u32 v7, v7, v1
  v_mul_u32_u24 v7, 32, v7
  v_and_b32 v1, 3, v0
  v_lshl_add_u32 v7, v1, 3, v7
  v_add_u32 v7, 40960, v7
  s_waitcnt vmcnt(0) lgkmcnt(0)
  ds_read_b128 v[16:19], v6 offset:0
  ds_read_b64_tr_b16 v[20:21], v7 offset:0
  ds_read_b64_tr_b16 v[22:23], v7 offset:128
  ds_read_b128 v[24:27], v6 offset:64
  ds_read_b64_tr_b16 v[28:29], v7 offset:1024
  ds_read_b64_tr_b16 v[30:31], v7 offset:1152
  ds_read_b128 v[32:35], v6 offset:128
  ds_read_b64_tr_b16 v[36:37], v7 offset:2048
  ds_read_b64_tr_b16 v[38:39], v7 offset:2176
  ds_read_b128 v[40:43], v6 offset:192
  ds_read_b64_tr_b16 v[44:45], v7 offset:3072
  ds_read_b64_tr_b16 v[46:47], v7 offset:3200
  ds_read_b128 v[48:51], v6 offset:256
  ds_read_b64_tr_b16 v[52:53], v7 offset:4096
  ds_read_b64_tr_b16 v[54:55], v7 offset:4224
  ds_read_b128 v[56:59], v6 offset:320
  ds_read_b64_tr_b16 v[60:61], v7 offset:5120
  ds_read_b64_tr_b16 v[62:63], v7 offset:5248
  ds_read_b128 v[64:67], v6 offset:384
  ds_read_b64_tr_b16 v[68:69], v7 offset:6144
  ds_read_b64_tr_b16 v[70:71], v7 offset:6272
  ds_read_b128 v[72:75], v6 offset:448
  ds_read_b64_tr_b16 v[76:77], v7 offset:7168
  ds_read_b64_tr_b16 v[78:79], v7 offset:7296
  ds_read_b128 v[80:83], v6 offset:512
  ds_read_b64_tr_b16 v[84:85], v7 offset:8192
  ds_read_b64_tr_b16 v[86:87], v7 offset:8320
  ds_read_b128 v[88:91], v6 offset:576
  ds_read_b64_tr_b16 v[92:93], v7 offset:9216
  ds_read_b64_tr_b16 v[94:95], v7 offset:9344
  s_waitcnt lgkmcnt(0)
  v_mfma_f32_16x16x32_bf16 v[12:15], v[16:19], v[20:23], 0
  v_mfma_f32_16x16x32_bf16 v[12:15], v[24:27], v[28:31], v[12:15]
  v_mfma_f32_16x16x32_bf16 v[12:15], v[32:35], v[36:39], v[12:15]
  v_mfma_f32_16x16x32_bf16 v[12:15], v[40:43], v[44:47], v[12:15]
  v_mfma_f32_16x16x32_bf16 v[12:15], v[48:51], v[52:55], v[12:15]
  v_mfma_f32_16x16x32_bf16 v[12:15], v[56:59], v[60:63], v[12:15]
  v_mfma_f32_16x16x32_bf16 v[12:15], v[64:67], v[68:71], v[12:15]
  v_mfma_f32_16x16x32_bf16 v[12:15], v[72:75], v[76:79], v[12:15]
  v_mfma_f32_16x16x32_bf16 v[12:15], v[80:83], v[84:87], v[12:15]
  v_mfma_f32_16x16x32_bf16 v[12:15], v[88:91], v[92:95], v[12:15]
  ds_read_b128 v[16:19], v6 offset:640
  ds_read_b64_tr_b16 v[20:21], v7 offset:10240
  ds_read_b64_tr_b16 v[22:23], v7 offset:10368
  ds_read_b128 v[24:27], v6 offset:704
  ds_read_b64_tr_b16 v[28:29], v7 offset:11264
  ds_read_b64_tr_b16 v[30:31], v7 offset:11392
  ds_read_b128 v[32:35], v6 offset:768
  ds_read_b64_tr_b16 v[36:37], v7 offset:12288
  ds_read_b64_tr_b16 v[38:39], v7 offset:12416
  ds_read_b128 v[40:43], v6 offset:832
  ds_read_b64_tr_b16 v[44:45], v7 offset:13312
  ds_read_b64_tr_b16 v[46:47], v7 offset:13440
  ds_read_b128 v[48:51], v6 offset:896
  ds_read_b64_tr_b16 v[52:53], v7 offset:14336
  ds_read_b64_tr_b16 v[54:55], v7 offset:14464
  ds_read_b128 v[56:59], v6 offset:960
  ds_read_b64_tr_b16 v[60:61], v7 offset:15360
  ds_read_b64_tr_b16 v[62:63], v7 offset:15488
  ds_read_b128 v[64:67], v6 offset:1024
  ds_read_b64_tr_b16 v[68:69], v7 offset:16384
  ds_read_b64_tr_b16 v[70:71], v7 offset:16512
  ds_read_b128 v[72:75], v6 offset:1088
  ds_read_b64_tr_b16 v[76:77], v7 offset:17408
  ds_read_b64_tr_b16 v[78:79], v7 offset:17536
  ds_read_b128 v[80:83], v6 offset:1152
  ds_read_b64_tr_b16 v[84:85], v7 offset:18432
  ds_read_b64_tr_b16 v[86:87], v7 offset:18560
  ds_read_b128 v[88:91], v6 offset:1216
  ds_read_b64_tr_b16 v[92:93], v7 offset:19456
  ds_read_b64_tr_b16 v[94:95], v7 offset:19584
  s_waitcnt lgkmcnt(0)
  v_mfma_f32_16x16x32_bf16 v[12:15], v[16:19], v[20:23], v[12:15]
  v_mfma_f32_16x16x32_bf16 v[12:15], v[24:27], v[28:31], v[12:15]
  v_mfma_f32_16x16x32_bf16 v[12:15], v[32:35], v[36:39], v[12:15]
  v_mfma_f32_16x16x32_bf16 v[12:15], v[40:43], v[44:47], v[12:15]
  v_mfma_f32_16x16x32_bf16 v[12:15], v[48:51], v[52:55], v[12:15]
  v_mfma_f32_16x16x32_bf16 v[12:15], v[56:59], v[60:63], v[12:15]
  v_mfma_f32_16x16x32_bf16 v[12:15], v[64:67], v[68:71], v[12:15]
  v_mfma_f32_16x16x32_bf16 v[12:15], v[72:75], v[76:79], v[12:15]
  v_mfma_f32_16x16x32_bf16 v[12:15], v[80:83], v[84:87], v[12:15]
  v_mfma_f32_16x16x32_bf16 v[12:15], v[88:91], v[92:95], v[12:15]
  s_nop 7
  v_cvt_pk_bf16_f32 v4, v12, v13
  v_mov_b32 v5, s30
  s_lshl_b32 s52, s65, 7
  s_add_u32 s52, s52, 393216
  v_lshlrev_b32 v1, 3, v0
  s_mov_b64 exec, 0xffff
  buffer_store_dwordx2 v[4:5], v1, s[36:39], s52 offen sc1
  s_mov_b64 exec, -1
  s_branch L_hb2
L_hwo:
  s_mov_b32 s40, s12
  s_and_b32 s41, s13, 0xffff
  s_mov_b32 s42, 0x500000
  s_mov_b32 s43, 0x20000
  v_lshrrev_b32 v1, 4, v0
  v_mul_u32_u24 v2, 1280, v1
  v_and_b32 v1, 15, v0
  v_lshl_add_u32 v2, v1, 4, v2
  s_mul_i32 s52, s32, 163840
  s_lshl_b32 s57, s33, 8
  s_add_u32 s52, s52, s57
  s_mov_b32 m0, 61440
  s_nop 0
  buffer_load_dwordx4 v2, s[40:43], s52 offen nt lds
  s_mov_b32 m0, 62464
  s_add_u32 s52, s52, 5120
  buffer_load_dwordx4 v2, s[40:43], s52 offen nt lds
  s_mov_b32 m0, 63488
  s_add_u32 s52, s52, 5120
  buffer_load_dwordx4 v2, s[40:43], s52 offen nt lds
  s_mov_b32 m0, 64512
  s_add_u32 s52, s52, 5120
  buffer_load_dwordx4 v2, s[40:43], s52 offen nt lds
  s_mov_b32 m0, 65536
  s_add_u32 s52, s52, 5120
  buffer_load_dwordx4 v2, s[40:43], s52 offen nt lds
  s_mov_b32 m0, 66560
  s_add_u32 s52, s52, 5120
  buffer_load_dwordx4 v2, s[40:43], s52 offen nt lds
  s_mov_b32 m0, 67584
  s_add_u32 s52, s52, 5120
  buffer_load_dwordx4 v2, s[40:43], s52 offen nt lds
  s_mov_b32 m0, 68608
  s_add_u32 s52, s52, 5120
  buffer_load_dwordx4 v2, s[40:43], s52 offen nt lds
  s_mov_b32 m0, 69632
  s_add_u32 s52, s52, 5120
  buffer_load_dwordx4 v2, s[40:43], s52 offen nt lds
  s_mov_b32 m0, 70656
  s_add_u32 s52, s52, 5120
  buffer_load_dwordx4 v2, s[40:43], s52 offen nt lds
  s_mov_b32 m0, 71680
  s_add_u32 s52, s52, 5120
  buffer_load_dwordx4 v2, s[40:43], s52 offen nt lds
  s_mov_b32 m0, 72704
  s_add_u32 s52, s52, 5120
  buffer_load_dwordx4 v2, s[40:43], s52 offen nt lds
  s_mov_b32 m0, 73728
  s_add_u32 s52, s52, 5120
  buffer_load_dwordx4 v2, s[40:43], s52 offen nt lds
  s_mov_b32 m0, 74752
  s_add_u32 s52, s52, 5120
  buffer_load_dwordx4 v2, s[40:43], s52 offen nt lds
  s_mov_b32 m0, 75776
  s_add_u32 s52, s52, 5120
  buffer_load_dwordx4 v2, s[40:43], s52 offen nt lds
  s_mov_b32 m0, 76800
  s_add_u32 s52, s52, 5120
  buffer_load_dwordx4 v2, s[40:43], s52 offen nt lds
  s_mov_b32 m0, 77824
  s_add_u32 s52, s52, 5120
  buffer_load_dwordx4 v2, s[40:43], s52 offen nt lds
  s_mov_b32 m0, 78848
  s_add_u32 s52, s52, 5120
  buffer_load_dwordx4 v2, s[40:43], s52 offen nt lds
  s_mov_b32 m0, 79872
  s_add_u32 s52, s52, 5120
  buffer_load_dwordx4 v2, s[40:43], s52 offen nt lds
  s_mov_b32 m0, 80896
  s_add_u32 s52, s52, 5120
  buffer_load_dwordx4 v2, s[40:43], s52 offen nt lds
  s_mov_b32 m0, 81920
  s_add_u32 s52, s52, 5120
  buffer_load_dwordx4 v2, s[40:43], s52 offen nt lds
  s_mov_b32 m0, 82944
  s_add_u32 s52, s52, 5120
  buffer_load_dwordx4 v2, s[40:43], s52 offen nt lds
  s_mov_b32 m0, 83968
  s_add_u32 s52, s52, 5120
  buffer_load_dwordx4 v2, s[40:43], s52 offen nt lds
  s_mov_b32 m0, 84992
  s_add_u32 s52, s52, 5120
  buffer_load_dwordx4 v2, s[40:43], s52 offen nt lds
  s_mov_b32 m0, 86016
  s_add_u32 s52, s52, 5120
  buffer_load_dwordx4 v2, s[40:43], s52 offen nt lds
  s_mov_b32 m0, 87040
  s_add_u32 s52, s52, 5120
  buffer_load_dwordx4 v2, s[40:43], s52 offen nt lds
  s_mov_b32 m0, 88064
  s_add_u32 s52, s52, 5120
  buffer_load_dwordx4 v2, s[40:43], s52 offen nt lds
  s_mov_b32 m0, 89088
  s_add_u32 s52, s52, 5120
  buffer_load_dwordx4 v2, s[40:43], s52 offen nt lds
  s_mov_b32 m0, 90112
  s_add_u32 s52, s52, 5120
  buffer_load_dwordx4 v2, s[40:43], s52 offen nt lds
  s_mov_b32 m0, 91136
  s_add_u32 s52, s52, 5120
  buffer_load_dwordx4 v2, s[40:43], s52 offen nt lds
  s_mov_b32 m0, 92160
  s_add_u32 s52, s52, 5120
  buffer_load_dwordx4 v2, s[40:43], s52 offen nt lds
  s_mov_b32 m0, 93184
  s_add_u32 s52, s52, 5120
  buffer_load_dwordx4 v2, s[40:43], s52 offen nt lds
  s_branch L_hb2
L_hffn:
  s_cmp_eq_u32 s31, 7
  s_cbranch_scc1 L_hdown
  s_cmp_eq_u32 s31, 5
  s_cselect_b32 s40, s16, s18
  s_cselect_b32 s41, s17, s19
  s_mov_b32 s53, 61440
  s_cselect_b32 s53, 20480, s53
  s_and_b32 s41, s41, 0xffff
  s_mov_b32 s42, 2211840
  s_mov_b32 s43, 0x20000
  v_lshrrev_b32 v1, 2, v0
  v_mul_u32_u24 v2, 3456, v1
  v_and_b32 v1, 3, v0
  v_lshl_add_u32 v2, v1, 4, v2
  s_lshl_b32 s52, s35, 6
  s_mov_b32 m0, s53
  s_nop 0
  buffer_load_dwordx4 v2, s[40:43], s52 offen nt lds
  s_add_u32 s53, s53, 1024
  s_add_u32 s52, s52, 55296
  s_mov_b32 m0, s53
  s_nop 0
  buffer_load_dwordx4 v2, s[40:43], s52 offen nt lds
  s_add_u32 s53, s53, 1024
  s_add_u32 s52, s52, 55296
  s_mov_b32 m0, s53
  s_nop 0
  buffer_load_dwordx4 v2, s[40:43], s52 offen nt lds
  s_add_u32 s53, s53, 1024
  s_add_u32 s52, s52, 55296
  s_mov_b32 m0, s53
  s_nop 0
  buffer_load_dwordx4 v2, s[40:43], s52 offen nt lds
  s_add_u32 s53, s53, 1024
  s_add_u32 s52, s52, 55296
  s_mov_b32 m0, s53
  s_nop 0
  buffer_load_dwordx4 v2, s[40:43], s52 offen nt lds
  s_add_u32 s53, s53, 1024
  s_add_u32 s52, s52, 55296
  s_mov_b32 m0, s53
  s_nop 0
  buffer_load_dwordx4 v2, s[40:43], s52 offen nt lds
  s_add_u32 s53, s53, 1024
  s_add_u32 s52, s52, 55296
  s_mov_b32 m0, s53
  s_nop 0
  buffer_load_dwordx4 v2, s[40:43], s52 offen nt lds
  s_add_u32 s53, s53, 1024
  s_add_u32 s52, s52, 55296
  s_mov_b32 m0, s53
  s_nop 0
  buffer_load_dwordx4 v2, s[40:43], s52 offen nt lds
  s_add_u32 s53, s53, 1024
  s_add_u32 s52, s52, 55296
  s_mov_b32 m0, s53
  s_nop 0
  buffer_load_dwordx4 v2, s[40:43], s52 offen nt lds
  s_add_u32 s53, s53, 1024
  s_add_u32 s52, s52, 55296
  s_mov_b32 m0, s53
  s_nop 0
  buffer_load_dwordx4 v2, s[40:43], s52 offen nt lds
  s_add_u32 s53, s53, 1024
  s_add_u32 s52, s52, 55296
  s_mov_b32 m0, s53
  s_nop 0
  buffer_load_dwordx4 v2, s[40:43], s52 offen nt lds
  s_add_u32 s53, s53, 1024
  s_add_u32 s52, s52, 55296
  s_mov_b32 m0, s53
  s_nop 0
  buffer_load_dwordx4 v2, s[40:43], s52 offen nt lds
  s_add_u32 s53, s53, 1024
  s_add_u32 s52, s52, 55296
  s_mov_b32 m0, s53
  s_nop 0
  buffer_load_dwordx4 v2, s[40:43], s52 offen nt lds
  s_add_u32 s53, s53, 1024
  s_add_u32 s52, s52, 55296
  s_mov_b32 m0, s53
  s_nop 0
  buffer_load_dwordx4 v2, s[40:43], s52 offen nt lds
  s_add_u32 s53, s53, 1024
  s_add_u32 s52, s52, 55296
  s_mov_b32 m0, s53
  s_nop 0
  buffer_load_dwordx4 v2, s[40:43], s52 offen nt lds
  s_add_u32 s53, s53, 1024
  s_add_u32 s52, s52, 55296
  s_mov_b32 m0, s53
  s_nop 0
  buffer_load_dwordx4 v2, s[40:43], s52 offen nt lds
  s_add_u32 s53, s53, 1024
  s_add_u32 s52, s52, 55296
  s_mov_b32 m0, s53
  s_nop 0
  buffer_load_dwordx4 v2, s[40:43], s52 offen nt lds
  s_add_u32 s53, s53, 1024
  s_add_u32 s52, s52, 55296
  s_mov_b32 m0, s53
  s_nop 0
  buffer_load_dwordx4 v2, s[40:43], s52 offen nt lds
  s_add_u32 s53, s53, 1024
  s_add_u32 s52, s52, 55296
  s_mov_b32 m0, s53
  s_nop 0
  buffer_load_dwordx4 v2, s[40:43], s52 offen nt lds
  s_add_u32 s53, s53, 1024
  s_add_u32 s52, s52, 55296
  s_mov_b32 m0, s53
  s_nop 0
  buffer_load_dwordx4 v2, s[40:43], s52 offen nt lds
  s_add_u32 s53, s53, 1024
  s_add_u32 s52, s52, 55296
  s_mov_b32 m0, s53
  s_nop 0
  buffer_load_dwordx4 v2, s[40:43], s52 offen nt lds
  s_add_u32 s53, s53, 1024
  s_add_u32 s52, s52, 55296
  s_mov_b32 m0, s53
  s_nop 0
  buffer_load_dwordx4 v2, s[40:43], s52 offen nt lds
  s_add_u32 s53, s53, 1024
  s_add_u32 s52, s52, 55296
  s_mov_b32 m0, s53
  s_nop 0
  buffer_load_dwordx4 v2, s[40:43], s52 offen nt lds
  s_add_u32 s53, s53, 1024
  s_add_u32 s52, s52, 55296
  s_mov_b32 m0, s53
  s_nop 0
  buffer_load_dwordx4 v2, s[40:43], s52 offen nt lds
  s_add_u32 s53, s53, 1024
  s_add_u32 s52, s52, 55296
  s_mov_b32 m0, s53
  s_nop 0
  buffer_load_dwordx4 v2, s[40:43], s52 offen nt lds
  s_add_u32 s53, s53, 1024
  s_add_u32 s52, s52, 55296
  s_mov_b32 m0, s53
  s_nop 0
  buffer_load_dwordx4 v2, s[40:43], s52 offen nt lds
  s_add_u32 s53, s53, 1024
  s_add_u32 s52, s52, 55296
  s_mov_b32 m0, s53
  s_nop 0
  buffer_load_dwordx4 v2, s[40:43], s52 offen nt lds
  s_add_u32 s53, s53, 1024
  s_add_u32 s52, s52, 55296
  s_mov_b32 m0, s53
  s_nop 0
  buffer_load_dwordx4 v2, s[40:43], s52 offen nt lds
  s_add_u32 s53, s53, 1024
  s_add_u32 s52, s52, 55296
  s_mov_b32 m0, s53
  s_nop 0
  buffer_load_dwordx4 v2, s[40:43], s52 offen nt lds
  s_add_u32 s53, s53, 1024
  s_add_u32 s52, s52, 55296
  s_mov_b32 m0, s53
  s_nop 0
  buffer_load_dwordx4 v2, s[40:43], s52 offen nt lds
  s_add_u32 s53, s53, 1024
  s_add_u32 s52, s52, 55296
  s_mov_b32 m0, s53
  s_nop 0
  buffer_load_dwordx4 v2, s[40:43], s52 offen nt lds
  s_add_u32 s53, s53, 1024
  s_add_u32 s52, s52, 55296
  s_mov_b32 m0, s53
  s_nop 0
  buffer_load_dwordx4 v2, s[40:43], s52 offen nt lds
  s_add_u32 s53, s53, 1024
  s_add_u32 s52, s52, 55296
  s_mov_b32 m0, s53
  s_nop 0
  buffer_load_dwordx4 v2, s[40:43], s52 offen nt lds
  s_add_u32 s53, s53, 1024
  s_add_u32 s52, s52, 55296
  s_mov_b32 m0, s53
  s_nop 0
  buffer_load_dwordx4 v2, s[40:43], s52 offen nt lds
  s_add_u32 s53, s53, 1024
  s_add_u32 s52, s52, 55296
  s_mov_b32 m0, s53
  s_nop 0
  buffer_load_dwordx4 v2, s[40:43], s52 offen nt lds
  s_add_u32 s53, s53, 1024
  s_add_u32 s52, s52, 55296
  s_mov_b32 m0, s53
  s_nop 0
  buffer_load_dwordx4 v2, s[40:43], s52 offen nt lds
  s_add_u32 s53, s53, 1024
  s_add_u32 s52, s52, 55296
  s_mov_b32 m0, s53
  s_nop 0
  buffer_load_dwordx4 v2, s[40:43], s52 offen nt lds
  s_add_u32 s53, s53, 1024
  s_add_u32 s52, s52, 55296
  s_mov_b32 m0, s53
  s_nop 0
  buffer_load_dwordx4 v2, s[40:43], s52 offen nt lds
  s_add_u32 s53, s53, 1024
  s_add_u32 s52, s52, 55296
  s_mov_b32 m0, s53
  s_nop 0
  buffer_load_dwordx4 v2, s[40:43], s52 offen nt lds
  s_add_u32 s53, s53, 1024
  s_add_u32 s52, s52, 55296
  s_mov_b32 m0, s53
  s_nop 0
  buffer_load_dwordx4 v2, s[40:43], s52 offen nt lds
  s_add_u32 s53, s53, 1024
  s_add_u32 s52, s52, 55296
  s_cmp_eq_u32 s31, 5
  s_cbranch_scc1 L_h4f
  s_branch L_hb2
L_hdown:
  s_mov_b32 s40, s20
  s_and_b32 s41, s21, 0xffff
  s_mov_b32 s42, 0x21c000
  s_mov_b32 s43, 0x20000
  v_lshlrev_b32 v2, 4, v0
  s_mul_i32 s52, s35, 40960
  s_mov_b32 m0, 102400
  s_nop 0
  buffer_load_dwordx4 v2, s[40:43], s52 offen nt lds
  s_mov_b32 m0, 103424
  s_add_u32 s52, s52, 1024
  buffer_load_dwordx4 v2, s[40:43], s52 offen nt lds
  s_mov_b32 m0, 104448
  s_add_u32 s52, s52, 1024
  buffer_load_dwordx4 v2, s[40:43], s52 offen nt lds
  s_mov_b32 m0, 105472
  s_add_u32 s52, s52, 1024
  buffer_load_dwordx4 v2, s[40:43], s52 offen nt lds
  s_mov_b32 m0, 106496
  s_add_u32 s52, s52, 1024
  buffer_load_dwordx4 v2, s[40:43], s52 offen nt lds
  s_mov_b32 m0, 107520
  s_add_u32 s52, s52, 1024
  buffer_load_dwordx4 v2, s[40:43], s52 offen nt lds
  s_mov_b32 m0, 108544
  s_add_u32 s52, s52, 1024
  buffer_load_dwordx4 v2, s[40:43], s52 offen nt lds
  s_mov_b32 m0, 109568
  s_add_u32 s52, s52, 1024
  buffer_load_dwordx4 v2, s[40:43], s52 offen nt lds
  s_mov_b32 m0, 110592
  s_add_u32 s52, s52, 1024
  buffer_load_dwordx4 v2, s[40:43], s52 offen nt lds
  s_mov_b32 m0, 111616
  s_add_u32 s52, s52, 1024
  buffer_load_dwordx4 v2, s[40:43], s52 offen nt lds
  s_mov_b32 m0, 112640
  s_add_u32 s52, s52, 1024
  buffer_load_dwordx4 v2, s[40:43], s52 offen nt lds
  s_mov_b32 m0, 113664
  s_add_u32 s52, s52, 1024
  buffer_load_dwordx4 v2, s[40:43], s52 offen nt lds
  s_mov_b32 m0, 114688
  s_add_u32 s52, s52, 1024
  buffer_load_dwordx4 v2, s[40:43], s52 offen nt lds
  s_mov_b32 m0, 115712
  s_add_u32 s52, s52, 1024
  buffer_load_dwordx4 v2, s[40:43], s52 offen nt lds
  s_mov_b32 m0, 116736
  s_add_u32 s52, s52, 1024
  buffer_load_dwordx4 v2, s[40:43], s52 offen nt lds
  s_mov_b32 m0, 117760
  s_add_u32 s52, s52, 1024
  buffer_load_dwordx4 v2, s[40:43], s52 offen nt lds
  s_mov_b32 m0, 118784
  s_add_u32 s52, s52, 1024
  buffer_load_dwordx4 v2, s[40:43], s52 offen nt lds
  s_mov_b32 m0, 119808
  s_add_u32 s52, s52, 1024
  buffer_load_dwordx4 v2, s[40:43], s52 offen nt lds
  s_mov_b32 m0, 120832
  s_add_u32 s52, s52, 1024
  buffer_load_dwordx4 v2, s[40:43], s52 offen nt lds
  s_mov_b32 m0, 121856
  s_add_u32 s52, s52, 1024
  buffer_load_dwordx4 v2, s[40:43], s52 offen nt lds
  s_mov_b32 m0, 122880
  s_add_u32 s52, s52, 1024
  buffer_load_dwordx4 v2, s[40:43], s52 offen nt lds
  s_mov_b32 m0, 123904
  s_add_u32 s52, s52, 1024
  buffer_load_dwordx4 v2, s[40:43], s52 offen nt lds
  s_mov_b32 m0, 124928
  s_add_u32 s52, s52, 1024
  buffer_load_dwordx4 v2, s[40:43], s52 offen nt lds
  s_mov_b32 m0, 125952
  s_add_u32 s52, s52, 1024
  buffer_load_dwordx4 v2, s[40:43], s52 offen nt lds
  s_mov_b32 m0, 126976
  s_add_u32 s52, s52, 1024
  buffer_load_dwordx4 v2, s[40:43], s52 offen nt lds
  s_mov_b32 m0, 128000
  s_add_u32 s52, s52, 1024
  buffer_load_dwordx4 v2, s[40:43], s52 offen nt lds
  s_mov_b32 m0, 129024
  s_add_u32 s52, s52, 1024
  buffer_load_dwordx4 v2, s[40:43], s52 offen nt lds
  s_mov_b32 m0, 130048
  s_add_u32 s52, s52, 1024
  buffer_load_dwordx4 v2, s[40:43], s52 offen nt lds
  s_mov_b32 m0, 131072
  s_add_u32 s52, s52, 1024
  buffer_load_dwordx4 v2, s[40:43], s52 offen nt lds
  s_mov_b32 m0, 132096
  s_add_u32 s52, s52, 1024
  buffer_load_dwordx4 v2, s[40:43], s52 offen nt lds
  s_mov_b32 m0, 133120
  s_add_u32 s52, s52, 1024
  buffer_load_dwordx4 v2, s[40:43], s52 offen nt lds
  s_mov_b32 m0, 134144
  s_add_u32 s52, s52, 1024
  buffer_load_dwordx4 v2, s[40:43], s52 offen nt lds
  s_mov_b32 m0, 135168
  s_add_u32 s52, s52, 1024
  buffer_load_dwordx4 v2, s[40:43], s52 offen nt lds
  s_mov_b32 m0, 136192
  s_add_u32 s52, s52, 1024
  buffer_load_dwordx4 v2, s[40:43], s52 offen nt lds
  s_mov_b32 m0, 137216
  s_add_u32 s52, s52, 1024
  buffer_load_dwordx4 v2, s[40:43], s52 offen nt lds
  s_mov_b32 m0, 138240
  s_add_u32 s52, s52, 1024
  buffer_load_dwordx4 v2, s[40:43], s52 offen nt lds
  s_mov_b32 m0, 139264
  s_add_u32 s52, s52, 1024
  buffer_load_dwordx4 v2, s[40:43], s52 offen nt lds
  s_mov_b32 m0, 140288
  s_add_u32 s52, s52, 1024
  buffer_load_dwordx4 v2, s[40:43], s52 offen nt lds
  s_mov_b32 m0, 141312
  s_add_u32 s52, s52, 1024
  buffer_load_dwordx4 v2, s[40:43], s52 offen nt lds
  s_mov_b32 m0, 142336
  s_add_u32 s52, s52, 1024
  buffer_load_dwordx4 v2, s[40:43], s52 offen nt lds
  s_branch L_hb2
L_h4:
  s_cmp_eq_u32 s34, 1
  s_cbranch_scc1 L_h4f
  s_cmp_eq_u32 s34, 2
  s_cbranch_scc0 L_hb2
  s_mov_b32 s48, s4
  s_and_b32 s49, s5, 0xffff
  s_mov_b32 s50, 0xa00
  s_mov_b32 s51, 0x20000
  v_and_b32 v1, 15, v0
  v_lshlrev_b32 v9, 3, v1
  v_lshlrev_b32 v8, 1, v1
  v_bfe_u32 v6, v0, 4, 1
  v_mul_u32_u24 v7, 1280, v6
  v_add_u32 v8, v8, v7
  v_lshlrev_b32 v6, 4, v6
  s_lshl_b32 s57, s35, 5
  buffer_load_ushort v204, v8, s[48:51], s57 offen
  s_lshl_b32 s57, s35, 7
  s_add_u32 s58, s57, 403456
  s_add_u32 s57, s57, 418816
  s_mov_b32 s56, 60000
L_poll_10:
  buffer_load_dwordx2 v[200:201], v9, s[36:39], s58 offen sc1
  buffer_load_dwordx2 v[202:203], v9, s[36:39], s57 offen sc1
  s_waitcnt vmcnt(0)
  v_xor_b32 v10, s30, v201
  v_xor_b32 v11, s30, v203
  v_or_b32 v10, v10, v11
  v_cmp_ne_u32 vcc, 0, v10
  s_sub_u32 s56, s56, 1
  s_cmp_eq_u32 s56, 0
  s_cbranch_scc1 L_polld_11
  s_and_b64 vcc, exec, vcc
  s_cbranch_vccnz L_poll_10
L_polld_11:
  v_lshlrev_b32 v204, 16, v204
  v_lshrrev_b32 v200, v6, v200
  v_lshlrev_b32 v200, 16, v200
  v_lshrrev_b32 v202, v6, v202
  v_lshlrev_b32 v202, 16, v202
  s_branch L_hb2
L_h4f:
  v_lshlrev_b32 v9, 4, v0
  s_mov_b32 s68, 408576
  s_mov_b32 s69, 409600
  s_mov_b32 s70, 410624
  s_mov_b32 s71, 411648
  s_mov_b32 s72, 412672
  s_mov_b32 s74, 413696
  s_mov_b32 s75, 414720
  s_mov_b32 s76, 415744
  s_mov_b32 s77, 416768
  s_mov_b32 s78, 417792
  s_mov_b32 s56, 60000
L_poll_12:
  buffer_load_dwordx4 v[196:199], v9, s[36:39], s78 offen sc1
  s_waitcnt vmcnt(0)
  v_xor_b32 v10, s30, v197
  v_xor_b32 v11, s30, v199
  v_or_b32 v10, v10, v11
  v_cmp_ne_u32 vcc, 0, v10
  s_sub_u32 s56, s56, 1
  s_cmp_eq_u32 s56, 0
  s_cbranch_scc1 L_polld_13
  s_and_b64 vcc, exec, vcc
  s_cbranch_vccnz L_poll_12
L_polld_13:
  s_mov_b32 s56, 60000
L_poll_14:
  buffer_load_dwordx4 v[160:163], v9, s[36:39], s68 offen sc1
  buffer_load_dwordx4 v[164:167], v9, s[36:39], s69 offen sc1
  buffer_load_dwordx4 v[168:171], v9, s[36:39], s70 offen sc1
  buffer_load_dwordx4 v[172:175], v9, s[36:39], s71 offen sc1
  buffer_load_dwordx4 v[176:179], v9, s[36:39], s72 offen sc1
  buffer_load_dwordx4 v[180:183], v9, s[36:39], s74 offen sc1
  buffer_load_dwordx4 v[184:187], v9, s[36:39], s75 offen sc1
  buffer_load_dwordx4 v[188:191], v9, s[36:39], s76 offen sc1
  buffer_load_dwordx4 v[192:195], v9, s[36:39], s77 offen sc1
  buffer_load_dwordx4 v[196:199], v9, s[36:39], s78 offen sc1
  s_waitcnt vmcnt(0)
  v_max3_u32 v10, s30, v161, v163
  v_min3_u32 v11, s30, v161, v163
  v_max3_u32 v10, v10, v165, v167
  v_min3_u32 v11, v11, v165, v167
  v_max3_u32 v10, v10, v169, v171
  v_min3_u32 v11, v11, v169, v171
  v_max3_u32 v10, v10, v173, v175
  v_min3_u32 v11, v11, v173, v175
  v_max3_u32 v10, v10, v177, v179
  v_min3_u32 v11, v11, v177, v179
  v_max3_u32 v10, v10, v181, v183
  v_min3_u32 v11, v11, v181, v183
  v_max3_u32 v10, v10, v185, v187
  v_min3_u32 v11, v11, v185, v187
  v_max3_u32 v10, v10, v189, v191
  v_min3_u32 v11, v11, v189, v191
  v_max3_u32 v10, v10, v193, v195
  v_min3_u32 v11, v11, v193, v195
  v_max3_u32 v10, v10, v197, v199
  v_min3_u32 v11, v11, v197, v199
  v_xor_b32 v10, v10, v11
  v_cmp_ne_u32 vcc, 0, v10
  s_sub_u32 s56, s56, 1
  s_cmp_eq_u32 s56, 0
  s_cbranch_scc1 L_polld_15
  s_and_b64 vcc, exec, vcc
  s_cbranch_vccnz L_poll_14
L_polld_15:
  s_mov_b32 s57, 0x01000c0c
  s_cmp_eq_u32 s31, 5
  s_cselect_b32 s57, 0x03020c0c, s57
  v_perm_b32 v128, v160, v160, s57
  v_perm_b32 v140, v180, v180, s57
  v_add_f32 v140, 1.0, v140
  v_perm_b32 v129, v162, v162, s57
  v_perm_b32 v141, v182, v182, s57
  v_add_f32 v141, 1.0, v141
  v_cvt_pk_bf16_f32 v10, v140, v141
  v_and_b32 v141, 0xffff0000, v10
  v_lshlrev_b32 v140, 16, v10
  v_perm_b32 v130, v164, v164, s57
  v_perm_b32 v142, v184, v184, s57
  v_add_f32 v142, 1.0, v142
  v_perm_b32 v131, v166, v166, s57
  v_perm_b32 v143, v186, v186, s57
  v_add_f32 v143, 1.0, v143
  v_cvt_pk_bf16_f32 v10, v142, v143
  v_and_b32 v143, 0xffff0000, v10
  v_lshlrev_b32 v142, 16, v10
  v_perm_b32 v132, v168, v168, s57
  v_perm_b32 v144, v188, v188, s57
  v_add_f32 v144, 1.0, v144
  v_perm_b32 v133, v170, v170, s57
  v_perm_b32 v145, v190, v190, s57
  v_add_f32 v145, 1.0, v145
  v_cvt_pk_bf16_f32 v10, v144, v145
  v_and_b32 v145, 0xffff0000, v10
  v_lshlrev_b32 v144, 16, v10
  v_perm_b32 v134, v172, v172, s57
  v_perm_b32 v146, v192, v192, s57
  v_add_f32 v146, 1.0, v146
  v_perm_b32 v135, v174, v174, s57
  v_perm_b32 v147, v194, v194, s57
  v_add_f32 v147, 1.0, v147
  v_cvt_pk_bf16_f32 v10, v146, v147
  v_and_b32 v147, 0xffff0000, v10
  v_lshlrev_b32 v146, 16, v10
  v_perm_b32 v136, v176, v176, s57
  v_perm_b32 v148, v196, v196, s57
  v_add_f32 v148, 1.0, v148
  v_perm_b32 v137, v178, v178, s57
  v_perm_b32 v149, v198, v198, s57
  v_add_f32 v149, 1.0, v149
  v_cvt_pk_bf16_f32 v10, v148, v149
  v_and_b32 v149, 0xffff0000, v10
  v_lshlrev_b32 v148, 16, v10
L_hb2:
  s_waitcnt vmcnt(0) lgkmcnt(0)
  s_barrier
L_tail:
  s_cmp_lt_u32 s31, 2
  s_cbranch_scc0 L_t1d
  s_mov_b32 s57, s31
  s_mul_i32 s58, s57, 544
  s_add_u32 s58, s58, 148992
  v_lshlrev_b32 v1, 3, v0
  v_add_u32 v1, s58, v1
  v_mov_b32 v2, s58
  ds_read_b64 v[32:33], v1 offset:0
  ds_read_b64 v[64:65], v2 offset:512
  ds_read_b64 v[34:35], v1 offset:1088
  ds_read_b64 v[66:67], v2 offset:1600
  ds_read_b64 v[36:37], v1 offset:2176
  ds_read_b64 v[68:69], v2 offset:2688
  ds_read_b64 v[38:39], v1 offset:3264
  ds_read_b64 v[70:71], v2 offset:3776
  s_waitcnt lgkmcnt(0)
  v_max_f32 v18, v64, v66
  v_max_f32 v18, v18, v68
  v_max_f32 v18, v18, v70
  s_mov_b32 s55, 0x3e0293ee
  v_sub_f32 v64, v64, v18
  v_mul_f32 v64, s55, v64
  v_exp_f32 v64, v64
  v_sub_f32 v66, v66, v18
  v_mul_f32 v66, s55, v66
  v_exp_f32 v66, v66
  v_sub_f32 v68, v68, v18
  v_mul_f32 v68, s55, v68
  v_exp_f32 v68, v68
  v_sub_f32 v70, v70, v18
  v_mul_f32 v70, s55, v70
  v_exp_f32 v70, v70
  s_nop 0
  v_mul_f32 v16, v32, v64
  v_mul_f32 v17, v33, v64
  v_mul_f32 v19, v65, v64
  v_fma_f32 v16, v34, v66, v16
  v_fma_f32 v17, v35, v66, v17
  v_fma_f32 v19, v67, v66, v19
  v_fma_f32 v16, v36, v68, v16
  v_fma_f32 v17, v37, v68, v17
  v_fma_f32 v19, v69, v68, v19
  v_fma_f32 v16, v38, v70, v16
  v_fma_f32 v17, v39, v70, v17
  v_fma_f32 v19, v71, v70, v19
  v_max_f32 v20, 0xda24260, v19
  v_rcp_f32 v20, v20
  v_lshrrev_b32 v1, 3, v0
  v_lshlrev_b32 v1, 10, v1
  v_and_b32 v2, 7, v0
  v_lshl_add_u32 v1, v2, 3, v1
  v_mul_f32 v16, v16, v20
  v_mul_f32 v17, v17, v20
  v_cvt_pk_bf16_f32 v4, v16, v17
  v_mov_b32 v5, s30
  s_lshl_b32 s58, s33, 1
  s_add_u32 s58, s58, s31
  s_lshl_b32 s57, s32, 13
  s_lshl_b32 s59, s58, 6
  s_add_u32 s57, s57, s59
  s_add_u32 s57, s57, 524288
  buffer_store_dwordx2 v[4:5], v1, s[36:39], s57 offen sc1
  s_lshl_b32 s57, s32, 8
  s_lshl_b32 s59, s58, 4
  s_add_u32 s57, s57, s59
  s_add_u32 s57, s57, 786432
  v_mov_b32 v8, v18
  v_mov_b32 v9, s30
  v_mov_b32 v10, v19
  v_mov_b32 v11, s30
  s_mov_b64 exec, 1
  buffer_store_dwordx4 v[8:11], v1, s[36:39], s57 offen sc1
  s_mov_b64 exec, -1
L_t1d:
  s_cmp_eq_u32 s34, 0
  s_cbranch_scc1 L_t2
  s_cmp_eq_u32 s34, 1
  s_cbranch_scc1 L_t4
  s_cmp_eq_u32 s34, 2
  s_cbranch_scc0 L_fin
  s_cmp_eq_u32 s31, 4
  s_cbranch_scc0 L_fin
  v_lshlrev_b32 v9, 3, v0
  v_lshlrev_b32 v8, 4, v0
  v_bfe_u32 v6, v0, 4, 1
  v_and_b32 v1, 15, v0
  v_mul_u32_u24 v11, 2560, v6
  v_lshrrev_b32 v7, 1, v1
  v_lshl_add_u32 v11, v7, 3, v11
  v_mul_u32_u24 v13, 1280, v6
  v_lshl_add_u32 v13, v1, 1, v13
  v_mov_b32 v5, s30
  s_mov_b32 s48, s26
  s_and_b32 s49, s27, 0xffff
  s_mov_b32 s50, 0xa00
  s_mov_b32 s51, 0x20000
  s_lshl_b32 s59, s35, 6
  s_add_u32 s59, s59, 458752
  s_mul_i32 s66, s35, 14336
  s_add_u32 s66, s66, 1441792
  s_add_u32 s67, s66, 4096
  s_add_u32 s68, s66, 8192
  s_add_u32 s69, s66, 12288
  s_lshl_b32 s70, s35, 5
  v_mov_b32 v148, 0
  v_mov_b32 v149, 0
  v_mov_b32 v150, s30
  s_lshl_b32 s57, s35, 13
  s_add_u32 s57, s57, 1114112
  s_add_u32 s58, s57, 4096
  buffer_load_dwordx2 v[32:33], v9, s[36:39], s57 offen sc1
  buffer_load_dwordx2 v[34:35], v9, s[36:39], s57 offen offset:512 sc1
  buffer_load_dwordx2 v[36:37], v9, s[36:39], s57 offen offset:1024 sc1
  buffer_load_dwordx2 v[38:39], v9, s[36:39], s57 offen offset:1536 sc1
  buffer_load_dwordx2 v[40:41], v9, s[36:39], s57 offen offset:2048 sc1
  buffer_load_dwordx2 v[42:43], v9, s[36:39], s57 offen offset:2560 sc1
  buffer_load_dwordx2 v[44:45], v9, s[36:39], s57 offen offset:3072 sc1
  buffer_load_dwordx2 v[46:47], v9, s[36:39], s57 offen offset:3584 sc1
  buffer_load_dwordx2 v[48:49], v9, s[36:39], s58 offen sc1
  buffer_load_dwordx2 v[50:51], v9, s[36:39], s58 offen offset:512 sc1
  buffer_load_dwordx2 v[52:53], v9, s[36:39], s58 offen offset:1024 sc1
  buffer_load_dwordx2 v[54:55], v9, s[36:39], s58 offen offset:1536 sc1
  buffer_load_dwordx2 v[56:57], v9, s[36:39], s58 offen offset:2048 sc1
  buffer_load_dwordx2 v[58:59], v9, s[36:39], s58 offen offset:2560 sc1
  buffer_load_dwordx2 v[60:61], v9, s[36:39], s58 offen offset:3072 sc1
  buffer_load_dwordx2 v[62:63], v9, s[36:39], s58 offen offset:3584 sc1
  s_mov_b32 s56, 60000
L_pp_16:
  s_waitcnt vmcnt(0)
  v_max3_u32 v14, s30, v33, v35
  v_min3_u32 v15, s30, v33, v35
  v_max3_u32 v14, v14, v37, v39
  v_min3_u32 v15, v15, v37, v39
  v_max3_u32 v14, v14, v41, v43
  v_min3_u32 v15, v15, v41, v43
  v_max3_u32 v14, v14, v45, v47
  v_min3_u32 v15, v15, v45, v47
  v_max3_u32 v14, v14, v49, v51
  v_min3_u32 v15, v15, v49, v51
  v_max3_u32 v14, v14, v53, v55
  v_min3_u32 v15, v15, v53, v55
  v_max3_u32 v14, v14, v57, v59
  v_min3_u32 v15, v15, v57, v59
  v_max3_u32 v14, v14, v61, v63
  v_min3_u32 v15, v15, v61, v63
  v_cmp_ne_u32 vcc, v14, v15
  s_nop 0
  s_and_b64 vcc, exec, vcc
  s_cbranch_vccz L_ppj_17_g0
  buffer_load_dwordx2 v[32:33], v9, s[36:39], s57 offen sc1
  buffer_load_dwordx2 v[34:35], v9, s[36:39], s57 offen offset:512 sc1
  buffer_load_dwordx2 v[36:37], v9, s[36:39], s57 offen offset:1024 sc1
  buffer_load_dwordx2 v[38:39], v9, s[36:39], s57 offen offset:1536 sc1
  buffer_load_dwordx2 v[40:41], v9, s[36:39], s57 offen offset:2048 sc1
  buffer_load_dwordx2 v[42:43], v9, s[36:39], s57 offen offset:2560 sc1
  buffer_load_dwordx2 v[44:45], v9, s[36:39], s57 offen offset:3072 sc1
  buffer_load_dwordx2 v[46:47], v9, s[36:39], s57 offen offset:3584 sc1
  buffer_load_dwordx2 v[48:49], v9, s[36:39], s58 offen sc1
  buffer_load_dwordx2 v[50:51], v9, s[36:39], s58 offen offset:512 sc1
  buffer_load_dwordx2 v[52:53], v9, s[36:39], s58 offen offset:1024 sc1
  buffer_load_dwordx2 v[54:55], v9, s[36:39], s58 offen offset:1536 sc1
  buffer_load_dwordx2 v[56:57], v9, s[36:39], s58 offen offset:2048 sc1
  buffer_load_dwordx2 v[58:59], v9, s[36:39], s58 offen offset:2560 sc1
  buffer_load_dwordx2 v[60:61], v9, s[36:39], s58 offen offset:3072 sc1
  buffer_load_dwordx2 v[62:63], v9, s[36:39], s58 offen offset:3584 sc1
  s_sub_u32 s56, s56, 1
  s_cmp_eq_u32 s56, 0
  s_cbranch_scc0 L_pp_16
  s_waitcnt vmcnt(0)
L_ppj_17_g0:
  v_add_f32 v16, v32, v34
  v_add_f32 v17, v36, v38
  v_add_f32 v16, v16, v40
  v_add_f32 v17, v17, v42
  v_add_f32 v16, v16, v44
  v_add_f32 v17, v17, v46
  v_add_f32 v16, v16, v48
  v_add_f32 v17, v17, v50
  v_add_f32 v16, v16, v52
  v_add_f32 v17, v17, v54
  v_add_f32 v16, v16, v56
  v_add_f32 v17, v17, v58
  v_add_f32 v16, v16, v60
  v_add_f32 v17, v17, v62
L_ppj_17:
  v_add_f32 v16, v16, v17
  s_nop 0
  v_mov_b32 v17, v16
  s_nop 1
  v_permlane32_swap_b32 v16, v17
  s_nop 1
  v_add_f32 v16, v16, v17
  v_cvt_pk_bf16_f32 v18, v16, v16
  v_lshlrev_b32 v16, 16, v18
  v_mul_f32 v16, v16, v200
  v_cvt_pk_bf16_f32 v18, v16, v16
  v_lshlrev_b32 v16, 16, v18
  v_add_f32 v204, v204, v16
  v_cvt_pk_bf16_f32 v18, v204, v204
  v_lshlrev_b32 v204, 16, v18
  s_nop 1
  v_mov_b32_dpp v18, v204 quad_perm:[1,0,3,2] row_mask:0xf bank_mask:0xf
  v_cvt_pk_bf16_f32 v4, v204, v18
  s_mov_b32 exec_lo, 0x55555555
  s_mov_b32 exec_hi, 0
  buffer_store_dwordx2 v[4:5], v11, s[36:39], s59 offen sc1
  s_mov_b64 exec, -1
  s_waitcnt vmcnt(0)
  v_mov_b32 v72, 0
  v_mov_b32 v73, 0
  v_mov_b32 v74, s30
  buffer_load_dwordx3 v[96:98], v8, s[36:39], s66 offen sc1
  buffer_load_dwordx3 v[100:102], v8, s[36:39], s66 offen offset:1024 sc1
  buffer_load_dwordx3 v[104:106], v8, s[36:39], s66 offen offset:2048 sc1
  buffer_load_dwordx3 v[108:110], v8, s[36:39], s66 offen offset:3072 sc1
  buffer_load_dwordx3 v[112:114], v8, s[36:39], s67 offen sc1
  buffer_load_dwordx3 v[116:118], v8, s[36:39], s67 offen offset:1024 sc1
  buffer_load_dwordx3 v[120:122], v8, s[36:39], s67 offen offset:2048 sc1
  buffer_load_dwordx3 v[124:126], v8, s[36:39], s67 offen offset:3072 sc1
  buffer_load_dwordx3 v[128:130], v8, s[36:39], s68 offen sc1
  buffer_load_dwordx3 v[132:134], v8, s[36:39], s68 offen offset:1024 sc1
  buffer_load_dwordx3 v[136:138], v8, s[36:39], s68 offen offset:2048 sc1
  buffer_load_dwordx3 v[140:142], v8, s[36:39], s68 offen offset:3072 sc1
  buffer_load_dwordx3 v[144:146], v8, s[36:39], s69 offen sc1
  s_mov_b32 exec_hi, 0
  buffer_load_dwordx3 v[148:150], v8, s[36:39], s69 offen offset:1024 sc1
  s_mov_b64 exec, -1
  s_mov_b32 s56, 60000
L_pp_18:
  s_waitcnt vmcnt(0)
  v_max3_u32 v14, s30, v98, v102
  v_min3_u32 v15, s30, v98, v102
  v_max3_u32 v14, v14, v106, v110
  v_min3_u32 v15, v15, v106, v110
  v_max3_u32 v14, v14, v114, v118
  v_min3_u32 v15, v15, v114, v118
  v_max3_u32 v14, v14, v122, v126
  v_min3_u32 v15, v15, v122, v126
  v_max3_u32 v14, v14, v130, v134
  v_min3_u32 v15, v15, v130, v134
  v_max3_u32 v14, v14, v138, v142
  v_min3_u32 v15, v15, v138, v142
  v_max3_u32 v14, v14, v146, v150
  v_min3_u32 v15, v15, v146, v150
  v_cmp_ne_u32 vcc, v14, v15
  s_nop 0
  s_and_b64 vcc, exec, vcc
  s_cbranch_vccz L_ppj_19_g0
  buffer_load_dwordx3 v[96:98], v8, s[36:39], s66 offen sc1
  buffer_load_dwordx3 v[100:102], v8, s[36:39], s66 offen offset:1024 sc1
  buffer_load_dwordx3 v[104:106], v8, s[36:39], s66 offen offset:2048 sc1
  buffer_load_dwordx3 v[108:110], v8, s[36:39], s66 offen offset:3072 sc1
  buffer_load_dwordx3 v[112:114], v8, s[36:39], s67 offen sc1
  buffer_load_dwordx3 v[116:118], v8, s[36:39], s67 offen offset:1024 sc1
  buffer_load_dwordx3 v[120:122], v8, s[36:39], s67 offen offset:2048 sc1
  buffer_load_dwordx3 v[124:126], v8, s[36:39], s67 offen offset:3072 sc1
  buffer_load_dwordx3 v[128:130], v8, s[36:39], s68 offen sc1
  buffer_load_dwordx3 v[132:134], v8, s[36:39], s68 offen offset:1024 sc1
  buffer_load_dwordx3 v[136:138], v8, s[36:39], s68 offen offset:2048 sc1
  buffer_load_dwordx3 v[140:142], v8, s[36:39], s68 offen offset:3072 sc1
  buffer_load_dwordx3 v[144:146], v8, s[36:39], s69 offen sc1
  s_mov_b32 exec_hi, 0
  buffer_load_dwordx3 v[148:150], v8, s[36:39], s69 offen offset:1024 sc1
  s_mov_b64 exec, -1
  s_sub_u32 s56, s56, 1
  s_cmp_eq_u32 s56, 0
  s_cbranch_scc0 L_pp_18
  s_waitcnt vmcnt(0)
L_ppj_19_g0:
  v_add_f32 v16, v96, v100
  v_add_f32 v17, v97, v101
  v_add_f32 v16, v16, v104
  v_add_f32 v17, v17, v105
  v_add_f32 v16, v16, v108
  v_add_f32 v17, v17, v109
  v_add_f32 v16, v16, v112
  v_add_f32 v17, v17, v113
  v_add_f32 v16, v16, v116
  v_add_f32 v17, v17, v117
  v_add_f32 v16, v16, v120
  v_add_f32 v17, v17, v121
  v_add_f32 v16, v16, v124
  v_add_f32 v17, v17, v125
  v_add_f32 v16, v16, v128
  v_add_f32 v17, v17, v129
  v_add_f32 v16, v16, v132
  v_add_f32 v17, v17, v133
  v_add_f32 v16, v16, v136
  v_add_f32 v17, v17, v137
  v_add_f32 v16, v16, v140
  v_add_f32 v17, v17, v141
  v_add_f32 v16, v16, v144
  v_add_f32 v17, v17, v145
  v_add_f32 v16, v16, v148
  v_add_f32 v17, v17, v149
L_ppj_19:
  s_nop 1
  v_permlane16_swap_b32 v16, v17
  s_nop 1
  v_add_f32 v16, v16, v17
  s_nop 0
  v_mov_b32 v17, v16
  s_nop 1
  v_permlane32_swap_b32 v16, v17
  s_nop 1
  v_add_f32 v16, v16, v17
  v_cvt_pk_bf16_f32 v18, v16, v16
  v_lshlrev_b32 v16, 16, v18
  v_mul_f32 v16, v16, v202
  v_cvt_pk_bf16_f32 v18, v16, v16
  v_lshlrev_b32 v16, 16, v18
  v_add_f32 v16, v204, v16
  v_cvt_pk_bf16_f32 v4, v16, v16
  s_mov_b32 exec_lo, -1
  s_mov_b32 exec_hi, 0
  buffer_store_short v4, v13, s[48:51], s70 offen
  s_mov_b64 exec, -1
  s_cmp_eq_u32 s35, 0
  s_cbranch_scc0 L_fin
  v_mov_b32 v1, 0
  v_mov_b32 v4, s30
  s_mov_b64 exec, 1
  buffer_store_dword v4, v1, s[36:39], 0 offen sc1
  s_mov_b64 exec, -1
  s_branch L_fin
L_t2:
  s_lshl_b32 s57, s31, 5
  s_add_u32 s57, s57, 61440
  v_and_b32 v1, 1, v0
  v_mul_u32_u24 v2, 0, v1
  v_lshrrev_b32 v1, 4, v0
  v_lshl_add_u32 v2, v1, 4, v2
  v_add_u32 v2, 0, v2
  v_lshlrev_b32 v3, 3, v1
  v_bfe_u32 v1, v0, 2, 2
  v_add_u32 v3, v3, v1
  v_mul_u32_u24 v3, 256, v3
  v_and_b32 v1, 3, v0
  v_lshl_add_u32 v3, v1, 3, v3
  v_add_u32 v3, s57, v3
  ds_read_b64_tr_b16 v[40:41], v3 offset:0
  ds_read_b64_tr_b16 v[42:43], v3 offset:1024
  ds_read_b64_tr_b16 v[44:45], v3 offset:8192
  ds_read_b64_tr_b16 v[46:47], v3 offset:9216
  ds_read_b64_tr_b16 v[48:49], v3 offset:16384
  ds_read_b64_tr_b16 v[50:51], v3 offset:17408
  ds_read_b64_tr_b16 v[52:53], v3 offset:24576
  ds_read_b64_tr_b16 v[54:55], v3 offset:25600
  v_and_b32 v1, 15, v0
  v_mul_u32_u24 v2, 272, v1
  v_lshrrev_b32 v7, 4, v0
  v_lshl_add_u32 v2, v7, 4, v2
  v_lshlrev_b32 v7, 4, v7
  v_add_u32 v7, 4608, v7
  v_lshlrev_b32 v8, 4, v1
  v_lshlrev_b32 v10, 2, v1
  v_add_u32 v10, 4608, v10
  v_lshrrev_b32 v6, 2, v0
  v_mul_u32_u24 v6, 272, v6
  v_and_b32 v1, 3, v0
  v_lshl_add_u32 v6, v1, 3, v6
  s_lshl_b32 s57, s31, 5
  v_add_u32 v6, s57, v6
  v_lshlrev_b32 v9, 4, v0
  v_lshlrev_b32 v11, 3, v0
  v_mov_b32 v5, s30
  s_lshl_b32 s59, s33, 3
  s_add_u32 s59, s59, s31
  s_lshl_b32 s59, s59, 13
  s_lshl_b32 s58, s32, 8
  s_add_u32 s59, s59, s58
  s_add_u32 s59, s59, 1114112
  s_add_u32 s58, s58, 786432
  s_lshl_b32 s57, s32, 13
  s_lshl_b32 s66, s31, 10
  s_add_u32 s57, s57, s66
  s_add_u32 s57, s57, 524288
  s_cmp_eq_u32 s31, 7
  s_cbranch_scc1 L_t2w
  buffer_load_dwordx4 v[76:79], v9, s[36:39], s57 offen sc1
  s_mov_b32 s56, 60000
L_pp_20:
  s_waitcnt vmcnt(0)
  v_xor_b32 v14, s30, v77
  v_xor_b32 v15, s30, v79
  v_or_b32 v14, v14, v15
  v_cmp_ne_u32 vcc, 0, v14
  s_nop 0
  s_and_b64 vcc, exec, vcc
  s_cbranch_vccz L_ppj_21_g0
  buffer_load_dwordx4 v[76:79], v9, s[36:39], s57 offen sc1
  s_sub_u32 s56, s56, 1
  s_cmp_eq_u32 s56, 0
  s_cbranch_scc0 L_pp_20
  s_waitcnt vmcnt(0)
L_ppj_21_g0:
  ds_write2_b32 v6, v76, v78 offset0:0 offset1:1
L_ppj_21:
  s_branch L_t2b
L_t2w:
  buffer_load_dwordx4 v[76:79], v9, s[36:39], s57 offen sc1
  buffer_load_dwordx4 v[80:83], v8, s[36:39], s58 offen sc1
  s_mov_b32 s56, 60000
L_pp_22:
  s_waitcnt vmcnt(0)
  v_max3_u32 v14, s30, v77, v79
  v_min3_u32 v15, s30, v77, v79
  v_max3_u32 v14, v14, v81, v83
  v_min3_u32 v15, v15, v81, v83
  v_cmp_ne_u32 vcc, v14, v15
  s_nop 0
  s_and_b64 vcc, exec, vcc
  s_cbranch_vccz L_ppj_23_g0
  buffer_load_dwordx4 v[76:79], v9, s[36:39], s57 offen sc1
  buffer_load_dwordx4 v[80:83], v8, s[36:39], s58 offen sc1
  s_sub_u32 s56, s56, 1
  s_cmp_eq_u32 s56, 0
  s_cbranch_scc0 L_pp_22
  s_waitcnt vmcnt(0)
L_ppj_23_g0:
  ds_write2_b32 v6, v76, v78 offset0:0 offset1:1
  v_mov_b32 v36, v80
  v_mov_b32 v38, v82
L_ppj_23:
  s_nop 1
  v_max_f32_dpp v20, v36, v36 row_ror:2 row_mask:0xf bank_mask:0xf
  s_nop 1
  v_max_f32_dpp v20, v20, v20 row_ror:4 row_mask:0xf bank_mask:0xf
  s_nop 1
  v_max_f32_dpp v20, v20, v20 row_ror:8 row_mask:0xf bank_mask:0xf
  s_mov_b32 s55, 0x3e0293ee
  v_sub_f32 v21, v36, v20
  v_mul_f32 v21, s55, v21
  v_exp_f32 v21, v21
  s_nop 0
  v_mul_f32 v21, v21, v38
  s_nop 1
  v_add_f32_dpp v22, v21, v21 row_ror:2 row_mask:0xf bank_mask:0xf
  s_nop 1
  v_add_f32_dpp v22, v22, v22 row_ror:4 row_mask:0xf bank_mask:0xf
  s_nop 1
  v_add_f32_dpp v22, v22, v22 row_ror:8 row_mask:0xf bank_mask:0xf
  v_rcp_f32 v22, v22
  s_nop 0
  v_mul_f32 v21, v21, v22
  s_mov_b64 exec, 0xffff
  ds_write_b32 v10, v21
  s_mov_b64 exec, -1
L_t2b:
  s_waitcnt lgkmcnt(0)
  s_barrier
  ds_read_b128 v[56:59], v2 offset:0
  ds_read_b128 v[60:63], v2 offset:64
  ds_read_b128 v[64:67], v2 offset:128
  ds_read_b128 v[68:71], v2 offset:192
  ds_read_b128 v[72:75], v7
  s_waitcnt lgkmcnt(4)
  v_mfma_f32_16x16x32_bf16 v[12:15], v[56:59], v[40:43], 0
  s_waitcnt lgkmcnt(3)
  v_mfma_f32_16x16x32_bf16 v[12:15], v[60:63], v[44:47], v[12:15]
  s_waitcnt lgkmcnt(2)
  v_mfma_f32_16x16x32_bf16 v[12:15], v[64:67], v[48:51], v[12:15]
  s_waitcnt lgkmcnt(1)
  v_mfma_f32_16x16x32_bf16 v[12:15], v[68:71], v[52:55], v[12:15]
  s_waitcnt lgkmcnt(0)
  s_nop 7
  v_mul_f32 v16, v12, v72
  v_mul_f32 v17, v13, v73
  v_fma_f32 v16, v14, v74, v16
  v_fma_f32 v17, v15, v75, v17
  s_nop 1
  v_permlane16_swap_b32 v16, v17
  s_nop 1
  v_add_f32 v16, v16, v17
  s_nop 0
  v_mov_b32 v17, v16
  s_nop 1
  v_permlane32_swap_b32 v16, v17
  s_nop 1
  v_add_f32 v4, v16, v17
  s_mov_b32 exec_lo, -1
  s_mov_b32 exec_hi, 0
  buffer_store_dwordx2 v[4:5], v11, s[36:39], s59 offen sc1
  s_mov_b64 exec, -1
  s_branch L_fin
L_t4:
  s_mov_b32 s57, 20480
  s_bitcmp1_b32 s31, 2
  s_cselect_b32 s57, 61440, s57
  s_and_b32 s66, s31, 3
  s_mul_i32 s58, s66, 10240
  s_add_u32 s57, s57, s58
  v_and_b32 v1, 1, v0
  v_mul_u32_u24 v2, 1344, v1
  v_lshrrev_b32 v1, 4, v0
  v_lshl_add_u32 v2, v1, 4, v2
  v_add_u32 v2, 145920, v2
  v_lshlrev_b32 v3, 3, v1
  v_bfe_u32 v1, v0, 2, 2
  v_add_u32 v3, v3, v1
  v_mul_u32_u24 v3, 64, v3
  v_and_b32 v1, 3, v0
  v_lshl_add_u32 v3, v1, 3, v3
  v_add_u32 v3, s57, v3
  ds_read_b64_tr_b16 v[64:65], v3 offset:0
  ds_read_b64_tr_b16 v[66:67], v3 offset:256
  ds_read_b64_tr_b16 v[68:69], v3 offset:32
  ds_read_b64_tr_b16 v[70:71], v3 offset:288
  ds_read_b64_tr_b16 v[72:73], v3 offset:2048
  ds_read_b64_tr_b16 v[74:75], v3 offset:2304
  ds_read_b64_tr_b16 v[76:77], v3 offset:2080
  ds_read_b64_tr_b16 v[78:79], v3 offset:2336
  ds_read_b64_tr_b16 v[80:81], v3 offset:4096
  ds_read_b64_tr_b16 v[82:83], v3 offset:4352
  ds_read_b64_tr_b16 v[84:85], v3 offset:4128
  ds_read_b64_tr_b16 v[86:87], v3 offset:4384
  ds_read_b64_tr_b16 v[88:89], v3 offset:6144
  ds_read_b64_tr_b16 v[90:91], v3 offset:6400
  ds_read_b64_tr_b16 v[92:93], v3 offset:6176
  ds_read_b64_tr_b16 v[94:95], v3 offset:6432
  ds_read_b64_tr_b16 v[96:97], v3 offset:8192
  ds_read_b64_tr_b16 v[98:99], v3 offset:8448
  ds_read_b64_tr_b16 v[100:101], v3 offset:8224
  ds_read_b64_tr_b16 v[102:103], v3 offset:8480
  s_mul_i32 s58, s66, 320
  v_add_u32 v2, s58, v2
  s_waitcnt lgkmcnt(0)
  s_mul_i32 s57, s31, 160
  s_add_u32 s57, s57, 102400
  s_lshl_b32 s58, s31, 7
  s_add_u32 s58, s58, 151040
  v_and_b32 v1, 1, v0
  v_mul_u32_u24 v6, 64, v1
  v_lshrrev_b32 v1, 4, v0
  v_lshl_add_u32 v6, v1, 4, v6
  v_add_u32 v6, 0, v6
  v_lshlrev_b32 v7, 3, v1
  v_bfe_u32 v1, v0, 2, 2
  v_add_u32 v7, v7, v1
  v_mul_u32_u24 v7, 1280, v7
  v_and_b32 v1, 3, v0
  v_lshl_add_u32 v7, v1, 3, v7
  v_add_u32 v7, s57, v7
  v_add_u32 v6, s58, v6
  ds_read_b64_tr_b16 v[104:105], v7 offset:0
  ds_read_b64_tr_b16 v[106:107], v7 offset:5120
  ds_read_b64_tr_b16 v[108:109], v7 offset:32
  ds_read_b64_tr_b16 v[110:111], v7 offset:5152
  ds_read_b64_tr_b16 v[112:113], v7 offset:64
  ds_read_b64_tr_b16 v[114:115], v7 offset:5184
  ds_read_b64_tr_b16 v[116:117], v7 offset:96
  ds_read_b64_tr_b16 v[118:119], v7 offset:5216
  ds_read_b64_tr_b16 v[120:121], v7 offset:128
  ds_read_b64_tr_b16 v[122:123], v7 offset:5248
  v_and_b32 v1, 15, v0
  v_lshlrev_b32 v8, 4, v1
  s_lshl_b32 s57, s31, 8
  s_add_u32 s57, s57, 148992
  v_lshlrev_b32 v10, 3, v1
  v_add_u32 v10, s57, v10
  v_lshrrev_b32 v7, 5, v0
  v_and_b32 v1, 31, v0
  v_lshlrev_b32 v11, 3, v1
  v_lshl_add_u32 v11, v7, 2, v11
  v_add_u32 v11, 148992, v11
  v_lshlrev_b32 v7, 6, v7
  v_lshl_add_u32 v7, v1, 1, v7
  v_add_u32 v7, s58, v7
  s_mul_i32 s66, s31, 5
  s_mul_i32 s66, s66, 14336
  s_lshl_b32 s57, s35, 8
  s_add_u32 s66, s66, s57
  s_add_u32 s66, s66, 1441792
  s_add_u32 s67, s66, 14336
  s_add_u32 s68, s66, 28672
  s_add_u32 s69, s66, 43008
  s_add_u32 s70, s66, 57344
  s_waitcnt lgkmcnt(0)
  s_sub_u32 s57, s31, 4
  s_cmp_lt_u32 s57, 2
  s_cbranch_scc0 L_t4a
  s_mul_i32 s58, s57, 2560
  s_add_u32 s58, s58, 458752
  s_mul_i32 s57, s57, 1344
  s_add_u32 s57, s57, 145920
  v_lshlrev_b32 v9, 3, v0
  v_lshlrev_b32 v28, 2, v0
  v_add_u32 v28, s57, v28
  v_mov_b32 v61, 0x3acccccd
  buffer_load_dwordx2 v[150:151], v9, s[36:39], s58 offen sc1
  buffer_load_dwordx2 v[152:153], v9, s[36:39], s58 offen offset:512 sc1
  buffer_load_dwordx2 v[154:155], v9, s[36:39], s58 offen offset:1024 sc1
  buffer_load_dwordx2 v[156:157], v9, s[36:39], s58 offen offset:1536 sc1
  buffer_load_dwordx2 v[158:159], v9, s[36:39], s58 offen offset:2048 sc1
  s_mov_b32 s56, 60000
L_pp_24:
  s_waitcnt vmcnt(0)
  v_max3_u32 v14, s30, v151, v153
  v_min3_u32 v15, s30, v151, v153
  v_max3_u32 v14, v14, v155, v157
  v_min3_u32 v15, v15, v155, v157
  v_max3_u32 v14, v14, v159, v159
  v_min3_u32 v15, v15, v159, v159
  v_cmp_ne_u32 vcc, v14, v15
  s_nop 0
  s_and_b64 vcc, exec, vcc
  s_cbranch_vccz L_ppj_25_g0
  buffer_load_dwordx2 v[150:151], v9, s[36:39], s58 offen sc1
  buffer_load_dwordx2 v[152:153], v9, s[36:39], s58 offen offset:512 sc1
  buffer_load_dwordx2 v[154:155], v9, s[36:39], s58 offen offset:1024 sc1
  buffer_load_dwordx2 v[156:157], v9, s[36:39], s58 offen offset:1536 sc1
  buffer_load_dwordx2 v[158:159], v9, s[36:39], s58 offen offset:2048 sc1
  s_sub_u32 s56, s56, 1
  s_cmp_eq_u32 s56, 0
  s_cbranch_scc0 L_pp_24
  s_waitcnt vmcnt(0)
L_ppj_25_g0:
  v_and_b32 v45, 0xffff0000, v150
  v_lshlrev_b32 v44, 16, v150
  v_and_b32 v47, 0xffff0000, v152
  v_lshlrev_b32 v46, 16, v152
  v_and_b32 v49, 0xffff0000, v154
  v_lshlrev_b32 v48, 16, v154
  v_and_b32 v51, 0xffff0000, v156
  v_lshlrev_b32 v50, 16, v156
  v_and_b32 v53, 0xffff0000, v158
  v_lshlrev_b32 v52, 16, v158
L_ppj_25:
  v_pk_add_f32 v[56:57], v[44:45], v[46:47]
  v_pk_mul_f32 v[58:59], v[44:45], v[44:45]
  v_pk_fma_f32 v[58:59], v[46:47], v[46:47], v[58:59]
  v_pk_add_f32 v[56:57], v[56:57], v[48:49]
  v_pk_fma_f32 v[58:59], v[48:49], v[48:49], v[58:59]
  v_pk_add_f32 v[56:57], v[56:57], v[50:51]
  v_pk_fma_f32 v[58:59], v[50:51], v[50:51], v[58:59]
  v_pk_add_f32 v[56:57], v[56:57], v[52:53]
  v_pk_fma_f32 v[58:59], v[52:53], v[52:53], v[58:59]
  v_add_f32 v56, v56, v57
  v_add_f32 v58, v58, v59
  s_nop 0
  v_add_f32_dpp v57, v56, v56 row_ror:8 row_mask:0xf bank_mask:0xf
  v_add_f32_dpp v59, v58, v58 row_ror:8 row_mask:0xf bank_mask:0xf
  s_nop 0
  v_add_f32_dpp v57, v57, v57 row_ror:4 row_mask:0xf bank_mask:0xf
  v_add_f32_dpp v59, v59, v59 row_ror:4 row_mask:0xf bank_mask:0xf
  s_nop 0
  v_add_f32_dpp v57, v57, v57 row_ror:2 row_mask:0xf bank_mask:0xf
  v_add_f32_dpp v59, v59, v59 row_ror:2 row_mask:0xf bank_mask:0xf
  s_nop 0
  v_add_f32_dpp v57, v57, v57 row_ror:1 row_mask:0xf bank_mask:0xf
  v_add_f32_dpp v59, v59, v59 row_ror:1 row_mask:0xf bank_mask:0xf
  s_nop 0
  v_add_f32_dpp v57, v57, v57 row_bcast:15 row_mask:0xa bank_mask:0xf
  v_add_f32_dpp v59, v59, v59 row_bcast:15 row_mask:0xa bank_mask:0xf
  s_nop 0
  v_add_f32_dpp v57, v57, v57 row_bcast:31 row_mask:0xc bank_mask:0xf
  v_add_f32_dpp v59, v59, v59 row_bcast:31 row_mask:0xc bank_mask:0xf
  s_nop 0
  v_readlane_b32 s57, v57, 63
  v_readlane_b32 s58, v59, 63
  s_nop 1
  v_mul_f32 v60, s57, v61
  v_mul_f32 v62, s58, v61
  v_fma_f32 v62, -v60, v60, v62
  v_max_f32 v62, 0, v62
  v_cvt_pk_bf16_f32 v29, v60, v62
  v_and_b32 v62, 0xffff0000, v29
  v_lshlrev_b32 v60, 16, v29
  v_add_f32 v62, 0x3727c5ac, v62
  v_cvt_pk_bf16_f32 v29, v62, v62
  v_lshlrev_b32 v62, 16, v29
  v_sqrt_f32 v62, v62
  s_nop 0
  v_cvt_pk_bf16_f32 v29, v62, v62
  v_lshlrev_b32 v62, 16, v29
  v_rcp_f32 v62, v62
  v_pk_add_f32 v[44:45], v[44:45], v[60:61] op_sel_hi:[1,0] neg_lo:[0,1] neg_hi:[0,1]
  v_cvt_pk_bf16_f32 v29, v44, v45
  v_and_b32 v45, 0xffff0000, v29
  v_lshlrev_b32 v44, 16, v29
  v_pk_add_f32 v[46:47], v[46:47], v[60:61] op_sel_hi:[1,0] neg_lo:[0,1] neg_hi:[0,1]
  v_cvt_pk_bf16_f32 v30, v46, v47
  v_and_b32 v47, 0xffff0000, v30
  v_lshlrev_b32 v46, 16, v30
  v_pk_add_f32 v[48:49], v[48:49], v[60:61] op_sel_hi:[1,0] neg_lo:[0,1] neg_hi:[0,1]
  v_cvt_pk_bf16_f32 v29, v48, v49
  v_and_b32 v49, 0xffff0000, v29
  v_lshlrev_b32 v48, 16, v29
  v_pk_add_f32 v[50:51], v[50:51], v[60:61] op_sel_hi:[1,0] neg_lo:[0,1] neg_hi:[0,1]
  v_cvt_pk_bf16_f32 v30, v50, v51
  v_and_b32 v51, 0xffff0000, v30
  v_lshlrev_b32 v50, 16, v30
  v_pk_add_f32 v[52:53], v[52:53], v[60:61] op_sel_hi:[1,0] neg_lo:[0,1] neg_hi:[0,1]
  v_cvt_pk_bf16_f32 v29, v52, v53
  v_and_b32 v53, 0xffff0000, v29
  v_lshlrev_b32 v52, 16, v29
  v_pk_mul_f32 v[44:45], v[44:45], v[62:63] op_sel_hi:[1,0]
  v_cvt_pk_bf16_f32 v29, v44, v45
  v_and_b32 v45, 0xffff0000, v29
  v_lshlrev_b32 v44, 16, v29
  v_pk_mul_f32 v[44:45], v[44:45], v[140:141]
  v_cvt_pk_bf16_f32 v29, v44, v45
  v_and_b32 v45, 0xffff0000, v29
  v_lshlrev_b32 v44, 16, v29
  v_pk_add_f32 v[44:45], v[44:45], v[128:129]
  v_cvt_pk_bf16_f32 v32, v44, v45
  ds_write_b32 v28, v32 offset:0
  v_pk_mul_f32 v[46:47], v[46:47], v[62:63] op_sel_hi:[1,0]
  v_cvt_pk_bf16_f32 v29, v46, v47
  v_and_b32 v47, 0xffff0000, v29
  v_lshlrev_b32 v46, 16, v29
  v_pk_mul_f32 v[46:47], v[46:47], v[142:143]
  v_cvt_pk_bf16_f32 v29, v46, v47
  v_and_b32 v47, 0xffff0000, v29
  v_lshlrev_b32 v46, 16, v29
  v_pk_add_f32 v[46:47], v[46:47], v[130:131]
  v_cvt_pk_bf16_f32 v33, v46, v47
  ds_write_b32 v28, v33 offset:256
  v_pk_mul_f32 v[48:49], v[48:49], v[62:63] op_sel_hi:[1,0]
  v_cvt_pk_bf16_f32 v29, v48, v49
  v_and_b32 v49, 0xffff0000, v29
  v_lshlrev_b32 v48, 16, v29
  v_pk_mul_f32 v[48:49], v[48:49], v[144:145]
  v_cvt_pk_bf16_f32 v29, v48, v49
  v_and_b32 v49, 0xffff0000, v29
  v_lshlrev_b32 v48, 16, v29
  v_pk_add_f32 v[48:49], v[48:49], v[132:133]
  v_cvt_pk_bf16_f32 v34, v48, v49
  ds_write_b32 v28, v34 offset:512
  v_pk_mul_f32 v[50:51], v[50:51], v[62:63] op_sel_hi:[1,0]
  v_cvt_pk_bf16_f32 v29, v50, v51
  v_and_b32 v51, 0xffff0000, v29
  v_lshlrev_b32 v50, 16, v29
  v_pk_mul_f32 v[50:51], v[50:51], v[146:147]
  v_cvt_pk_bf16_f32 v29, v50, v51
  v_and_b32 v51, 0xffff0000, v29
  v_lshlrev_b32 v50, 16, v29
  v_pk_add_f32 v[50:51], v[50:51], v[134:135]
  v_cvt_pk_bf16_f32 v35, v50, v51
  ds_write_b32 v28, v35 offset:768
  v_pk_mul_f32 v[52:53], v[52:53], v[62:63] op_sel_hi:[1,0]
  v_cvt_pk_bf16_f32 v29, v52, v53
  v_and_b32 v53, 0xffff0000, v29
  v_lshlrev_b32 v52, 16, v29
  v_pk_mul_f32 v[52:53], v[52:53], v[148:149]
  v_cvt_pk_bf16_f32 v29, v52, v53
  v_and_b32 v53, 0xffff0000, v29
  v_lshlrev_b32 v52, 16, v29
  v_pk_add_f32 v[52:53], v[52:53], v[136:137]
  v_cvt_pk_bf16_f32 v36, v52, v53
  ds_write_b32 v28, v36 offset:1024
  s_waitcnt lgkmcnt(0)
L_t4a:
  s_barrier
  ds_read_b128 v[32:35], v2 offset:0
  ds_read_b128 v[36:39], v2 offset:64
  ds_read_b128 v[40:43], v2 offset:128
  ds_read_b128 v[44:47], v2 offset:192
  ds_read_b128 v[48:51], v2 offset:256
  s_waitcnt lgkmcnt(4)
  v_mfma_f32_16x16x32_bf16 v[12:15], v[32:35], v[64:67], 0
  v_mfma_f32_16x16x32_bf16 v[16:19], v[32:35], v[68:71], 0
  s_waitcnt lgkmcnt(3)
  v_mfma_f32_16x16x32_bf16 v[12:15], v[36:39], v[72:75], v[12:15]
  v_mfma_f32_16x16x32_bf16 v[16:19], v[36:39], v[76:79], v[16:19]
  s_waitcnt lgkmcnt(2)
  v_mfma_f32_16x16x32_bf16 v[12:15], v[40:43], v[80:83], v[12:15]
  v_mfma_f32_16x16x32_bf16 v[16:19], v[40:43], v[84:87], v[16:19]
  s_waitcnt lgkmcnt(1)
  v_mfma_f32_16x16x32_bf16 v[12:15], v[44:47], v[88:91], v[12:15]
  v_mfma_f32_16x16x32_bf16 v[16:19], v[44:47], v[92:95], v[16:19]
  s_waitcnt lgkmcnt(0)
  v_mfma_f32_16x16x32_bf16 v[12:15], v[48:51], v[96:99], v[12:15]
  v_mfma_f32_16x16x32_bf16 v[16:19], v[48:51], v[100:103], v[16:19]
  s_nop 7
  s_mov_b64 exec, 0xffff
  ds_write_b64 v10, v[12:13]
  ds_write_b64 v10, v[16:17] offset:128
  s_mov_b64 exec, -1
  s_waitcnt lgkmcnt(0)
  s_barrier
  ds_read2st64_b32 v[20:21], v11 offset0:0 offset1:1
  ds_read2st64_b32 v[22:23], v11 offset0:2 offset1:3
  ds_read2st64_b32 v[24:25], v11 offset0:4 offset1:5
  ds_read2st64_b32 v[26:27], v11 offset0:6 offset1:7
  s_waitcnt lgkmcnt(2)
  v_add_f32 v16, v20, v21
  v_add_f32 v18, v22, v23
  v_add_f32 v16, v16, v18
  s_waitcnt lgkmcnt(0)
  v_add_f32 v17, v24, v25
  v_add_f32 v18, v26, v27
  v_add_f32 v17, v17, v18
  v_cvt_pk_bf16_f32 v18, v16, v17
  v_and_b32 v17, 0xffff0000, v18
  v_lshlrev_b32 v16, 16, v18
  v_mul_f32 v18, 0xbfb8aa3b, v16
  v_exp_f32 v18, v18
  s_nop 0
  v_add_f32 v18, 1.0, v18
  v_rcp_f32 v18, v18
  s_nop 0
  v_mul_f32 v16, v16, v18
  v_cvt_pk_bf16_f32 v18, v16, v16
  v_lshlrev_b32 v16, 16, v18
  v_mul_f32 v16, v16, v17
  v_cvt_pk_bf16_f32 v16, v16, v16
  ds_write_b16 v7, v16
  s_waitcnt lgkmcnt(0)
  ds_read_b128 v[28:31], v6
  s_waitcnt lgkmcnt(0)
  v_mfma_f32_16x16x32_bf16 v[32:35], v[28:31], v[104:107], 0
  v_mfma_f32_16x16x32_bf16 v[36:39], v[28:31], v[108:111], 0
  v_mfma_f32_16x16x32_bf16 v[40:43], v[28:31], v[112:115], 0
  v_mfma_f32_16x16x32_bf16 v[44:47], v[28:31], v[116:119], 0
  v_mfma_f32_16x16x32_bf16 v[48:51], v[28:31], v[120:123], 0
  s_nop 4
  v_mov_b32 v34, s30
  v_mov_b32 v38, s30
  v_mov_b32 v42, s30
  v_mov_b32 v46, s30
  v_mov_b32 v50, s30
  s_mov_b64 exec, 0xffff
  buffer_store_dwordx3 v[32:34], v8, s[36:39], s66 offen sc1
  buffer_store_dwordx3 v[36:38], v8, s[36:39], s67 offen sc1
  buffer_store_dwordx3 v[40:42], v8, s[36:39], s68 offen sc1
  buffer_store_dwordx3 v[44:46], v8, s[36:39], s69 offen sc1
  buffer_store_dwordx3 v[48:50], v8, s[36:39], s70 offen sc1
  s_mov_b64 exec, -1
L_fin:
L_end:
  s_endpgm
.section .rodata,"a"
.p2align 6
.amdhsa_kernel adaLN_cond__mha_block_cached__swiglu_ffn__decode_kernel
  .amdhsa_next_free_vgpr 256
  .amdhsa_next_free_sgpr 102
  .amdhsa_accum_offset 256
  .amdhsa_group_segment_fixed_size 0
  .amdhsa_kernarg_size 112
  .amdhsa_user_sgpr_count 2
  .amdhsa_user_sgpr_kernarg_segment_ptr 1
  .amdhsa_system_sgpr_workgroup_id_x 1
.end_amdhsa_kernel
```
